```python
import torch

def _softmax(x, axis=-1):
    return torch.softmax(x, dim=axis)
def _gelu(x):
    return torch.nn.functional.gelu(x, approximate="tanh")
def _silu(x):
    return torch.nn.functional.silu(x)
def _sigmoid(x):
    return torch.sigmoid(x)
def _layernorm(x, axis=-1, eps=1e-5):
    m = x.mean(dim=axis, keepdim=True)
    v = x.var(dim=axis, keepdim=True, unbiased=False)
    return (x - m) / torch.sqrt(v + eps)
def _scatter_add(tgt, idx, src, axis=0):
    return tgt.clone().index_add_(axis, idx, src)
def _segment_sum(src, seg, n):
    out = torch.zeros((n,) + src.shape[1:], dtype=src.dtype)
    return out.index_add_(0, seg, src)
def _pad(x, pw):
    flat = tuple(v for pair in reversed(pw) for v in pair)
    return torch.nn.functional.pad(x, flat)

kernel_name = 'gated_mix__sliding_block_cached__dense_activation_silu__decode'

def setup_inputs():

    _w = (lambda a: (lambda t: t.to(torch.bfloat16) if t.is_floating_point() else t)(torch.as_tensor(a)))
    def _A_setup():
        B, Sq, D = 8, 1, 448
        Hq, Hkv, Sk, Dh = 16, 8, 4096, 256
        assert Hq % Hkv == 0, (Hq, Hkv)
        return {
            "x": _w((lambda *s: torch.randn(*s, dtype=torch.bfloat16) * 0.2)(B, Sq, D)),
            "k_cache": _w((lambda *s: torch.randn(*s, dtype=torch.bfloat16) * 3.2)(B, Hkv, Sk, Dh)),
            "v_cache": _w((lambda *s: torch.randn(*s, dtype=torch.bfloat16) * 3.2)(B, Hkv, Sk, Dh)),
            "wq": _w((lambda *s: torch.randn(*s, dtype=torch.bfloat16) * 3.2)(D, Hq * Dh) * (D ** -0.5)),
            "wo": _w((lambda *s: torch.randn(*s, dtype=torch.bfloat16) * 3.2)(Hq * Dh, D) * ((Hq * Dh) ** -0.5)),
        }
    _A_in = _A_setup()

    def _B_setup():
        B, S, D, F = 8, 1, 448, 1792
        return {
            "x": _w((lambda *s: torch.randn(*s, dtype=torch.bfloat16) * 0.2)(B, S, D)),
            "w1": _w((lambda *s: torch.randn(*s, dtype=torch.bfloat16) * 3.2)(D, F) * (D ** -0.5)),
            "w2": _w((lambda *s: torch.randn(*s, dtype=torch.bfloat16) * 3.2)(F, D) * (F ** -0.5)),
        }
    _B_in = _B_setup()

    return {
        "A_x": _A_in["x"],
        "A_k_cache": _A_in["k_cache"],
        "A_v_cache": _A_in["v_cache"],
        "A_wq": _A_in["wq"],
        "A_wo": _A_in["wo"],
        "B_x": _B_in["x"],
        "B_w1": _B_in["w1"],
        "B_w2": _B_in["w2"],
        "gate_w": _w((lambda *s: torch.randn(*s, dtype=torch.bfloat16) * 0.2)(448) * 16.0),
    }

def reference(A_x, A_k_cache, A_v_cache, A_wq, A_wo, B_x, B_w1, B_w2, gate_w):
    def _A_ref(x, k_cache, v_cache, wq, wo):
        B, Sq, D = x.shape
        Hq, Dh = 16, 256
        Hkv, Sk = k_cache.shape[1], k_cache.shape[2]
        W = min(4096, max(256, Sk // 4))
        rep = Hq // Hkv
        q = (lambda x, *d: x.permute(*d))((x @ wq).reshape(B, Sq, Hq, Dh), 0, 2, 1, 3)
        k = (lambda x, n, axis: torch.repeat_interleave(x, n, dim=axis))(k_cache[:, :, Sk - W:, :], rep, axis=1)
        v = (lambda x, n, axis: torch.repeat_interleave(x, n, dim=axis))(v_cache[:, :, Sk - W:, :], rep, axis=1)
        scores = torch.einsum("bhqd,bhkd->bhqk", q, k) * (Dh ** -0.5)
        p = _softmax(scores, axis=-1)
        o = torch.einsum("bhqk,bhkd->bhqd", p, v)
        return (lambda x, *d: x.permute(*d))(o, 0, 2, 1, 3).reshape(B, Sq, Hq * Dh) @ wo

    def _B_ref(x, w1, w2):
        h = torch.einsum("bsd,df->bsf", x, w1)
        h = _silu(h)
        out = torch.einsum("bsf,fd->bsd", h, w2)
        return out

    x = A_x
    g = _sigmoid((x * gate_w).sum(-1, keepdims=True))
    a = _A_ref(x, A_k_cache, A_v_cache, A_wq, A_wo)
    b = _B_ref(x, B_w1, B_w2)
    return g * a + (1 - g) * b
```

```asm
; @launch grid=(256,1,1) block=(768,1,1) lds=163328
.amdgcn_target "amdgcn-amd-amdhsa--gfx950"
.text
.globl gated_mix__sliding_block_cached__dense_activation_silu__decode_kernel
.p2align 8
.type gated_mix__sliding_block_cached__dense_activation_silu__decode_kernel,@function
gated_mix__sliding_block_cached__dense_activation_silu__decode_kernel:
L_code_start:
    s_cmp_ge_u32 s2, 256
    s_cbranch_scc1 L_exit
    v_lshrrev_b32 v1, 6, v0
    v_and_b32 v0, 63, v0
    v_lshlrev_b32 v162, 4, v0
    v_readfirstlane_b32 s3, v1
    v_mov_b32 v12, 0
    v_mov_b32 v13, 0
    v_mov_b32 v14, 0
    v_mov_b32 v15, 0
    s_cmp_lg_u32 s3, 0
    s_cbranch_scc1 L_p1
    ds_write_b128 v162, v[12:15]
    ds_write_b128 v162, v[12:15] offset:6144
    s_waitcnt lgkmcnt(0)
L_p1:
    s_load_dwordx16 s[4:19], s[0:1], 0
    s_load_dwordx8 s[20:27], s[0:1], 64
    s_and_b32 s30, s2, 7
    s_lshr_b32 s31, s2, 3
    s_and_b32 s56, s31, 3
    s_lshr_b32 s57, s31, 2
    s_lshl_b32 s58, s56, 3
    s_add_u32 s58, s58, s30
    s_lshl_b32 s59, s57, 3
    s_add_u32 s59, s59, s30
    v_lshrrev_b32 v2, 4, v0
    v_and_b32 v3, 15, v0
    s_cmp_eq_u32 s3, 0
    s_cbranch_scc1 L_C
    s_cmp_lt_u32 s3, 8
    s_cbranch_scc1 L_pS
    s_sub_u32 s60, s3, 8
    s_getpc_b64 s[36:37]
L_pc:
    s_sub_u32 s36, s36, L_pc-L_code_start
    s_subb_u32 s37, s37, 0
    s_mov_b32 s38, L_code_end-L_code_start
    s_mov_b32 s39, 0x20000
    s_and_b32 s47, s31, 3
    s_lshl_b32 s47, s47, 2
    s_add_u32 s47, s47, s60
    s_lshl_b32 s47, s47, 10
    buffer_load_dwordx4 v[164:167], v162, s[36:39], s47 offen
    s_barrier
    s_branch L_V
L_pS:
    s_barrier
    s_branch L_S
L_C:
    s_setprio 3
    v_lshlrev_b32 v8, 4, v0
    s_barrier
    v_and_b32 v4, 7, v3
    v_mul_u32_u24 v4, 896, v4
    v_lshl_add_u32 v4, v2, 4, v4
    v_lshrrev_b32 v9, 3, v0
    v_and_b32 v10, 7, v0
    v_lshlrev_b32 v5, 13, v9
    v_lshl_add_u32 v5, v10, 4, v5
    v_mul_u32_u24 v6, 3584, v9
    v_lshl_add_u32 v6, v10, 4, v6
    v_mov_b32 v9, 0x7f000000
    v_cmp_gt_u32 vcc, 56, v0
    s_and_b32 s64, s31, 7
    s_lshr_b32 s65, s31, 3
    v_cndmask_b32 v9, v9, v8, vcc
    s_lshl_b32 s60, s65, 20
    s_lshl_b32 s61, s30, 10
    s_add_u32 s60, s60, s61
    s_lshl_b32 s61, s64, 7
    s_add_u32 s60, s60, s61
    s_lshl_b32 s61, s65, 8
    s_cmp_lt_u32 s65, 3
    s_cselect_b32 s62, s61, 0x40000000
    s_lshl_b32 s63, s57, 7
    s_cmp_lt_u32 s57, 7
    s_cselect_b32 s63, s63, 0x40000000
    s_mul_i32 s66, s57, 229376
    s_lshl_b32 s67, s58, 7
    s_add_u32 s66, s66, s67
    s_cmp_lt_u32 s58, 28
    s_cselect_b32 s66, s66, 0x40000000
    s_mul_i32 s67, s57, 896
    s_waitcnt lgkmcnt(0)
    s_load_dword s29, s[26:27], 581632
    s_mov_b32 s32, s4
    s_mov_b32 s33, s5
    s_mov_b32 s34, 7168
    s_mov_b32 s35, 0x20000
    s_mov_b32 s36, s10
    s_mov_b32 s37, s11
    s_mov_b32 s38, 3670016
    s_mov_b32 s39, 0x20000
    s_mov_b32 s40, s16
    s_mov_b32 s41, s17
    s_mov_b32 s42, 1605632
    s_mov_b32 s43, 0x20000
    s_mov_b32 s48, s20
    s_mov_b32 s49, s21
    s_mov_b32 s50, 896
    s_mov_b32 s51, 0x20000
    s_mov_b32 m0, 147456-0
    s_nop 0
    buffer_load_dwordx4 v4, s[32:35], s61 offen offset:0 lds
    s_mov_b32 m0, 148480-64
    s_nop 0
    buffer_load_dwordx4 v4, s[32:35], s61 offen offset:64 lds
    s_mov_b32 m0, 149504-128
    s_nop 0
    buffer_load_dwordx4 v4, s[32:35], s62 offen offset:128 lds
    s_mov_b32 m0, 150528-192
    s_nop 0
    buffer_load_dwordx4 v4, s[32:35], s62 offen offset:192 lds
    s_mov_b32 m0, 151552-0
    s_nop 0
    buffer_load_dwordx4 v4, s[32:35], s63 offen offset:0 lds
    s_mov_b32 m0, 152576-64
    s_nop 0
    buffer_load_dwordx4 v4, s[32:35], s63 offen offset:64 lds
    s_mov_b32 s61, 8192
L_C_wq:
    s_mov_b32 m0, s61
    s_add_u32 s61, s61, 1024
    buffer_load_dwordx4 v5, s[36:39], s60 offen nt lds
    s_add_u32 s60, s60, 65536
    s_cmp_lg_u32 s61, 24576
    s_cbranch_scc1 L_C_wq
L_C_w1:
    s_mov_b32 m0, s61
    s_add_u32 s61, s61, 1024
    buffer_load_dwordx4 v6, s[40:43], s66 offen nt lds
    s_add_u32 s66, s66, 28672
    s_cmp_lg_u32 s61, 32768
    s_cbranch_scc1 L_C_w1
    buffer_load_dwordx4 v[132:135], v9, s[48:51], 0 offen
    buffer_load_dwordx4 v[136:139], v9, s[32:35], s67 offen
    v_mov_b32 v13, 1
    ds_write_b32 v12, v13 offset:12
    s_mov_b32 s44, s26
    s_mov_b32 s45, s27
    s_mov_b32 s46, 2883584
    s_mov_b32 s47, 0x20000
    s_mov_b32 s52, s22
    s_mov_b32 s53, s23
    s_mov_b32 s54, 7168
    s_mov_b32 s55, 0x20000
    v_mov_b32 v12, 0
    v_mov_b32 v13, 1
    s_waitcnt lgkmcnt(0)
    s_add_u32 s29, s29, 1
    s_and_b32 s28, s29, 0xff
    s_cselect_b32 s28, 0, 1
    s_add_u32 s29, s29, s28
    s_and_b32 s28, s29, 0xff
    v_mov_b32 v11, s29
    ds_write_b32 v12, v11 offset:28
    s_waitcnt vmcnt(10)
    ds_write_b32 v12, v13 offset:56
    s_waitcnt vmcnt(2)
    ds_write_b32 v12, v13 offset:60
    s_waitcnt vmcnt(0)
    v_lshlrev_b32 v16, 16, v132
    v_and_b32 v17, 0xffff0000, v132
    v_lshlrev_b32 v24, 16, v136
    v_and_b32 v25, 0xffff0000, v136
    v_lshlrev_b32 v18, 16, v133
    v_and_b32 v19, 0xffff0000, v133
    v_lshlrev_b32 v26, 16, v137
    v_and_b32 v27, 0xffff0000, v137
    v_lshlrev_b32 v20, 16, v134
    v_and_b32 v21, 0xffff0000, v134
    v_lshlrev_b32 v28, 16, v138
    v_and_b32 v29, 0xffff0000, v138
    v_lshlrev_b32 v22, 16, v135
    v_and_b32 v23, 0xffff0000, v135
    v_lshlrev_b32 v30, 16, v139
    v_and_b32 v31, 0xffff0000, v139
    v_mul_f32 v16, v16, v24
    v_mul_f32 v17, v17, v25
    v_mul_f32 v18, v18, v26
    v_mul_f32 v19, v19, v27
    v_mul_f32 v20, v20, v28
    v_mul_f32 v21, v21, v29
    v_mul_f32 v22, v22, v30
    v_mul_f32 v23, v23, v31
    v_cvt_pk_bf16_f32 v24, v16, v17
    v_cvt_pk_bf16_f32 v25, v18, v19
    v_cvt_pk_bf16_f32 v26, v20, v21
    v_cvt_pk_bf16_f32 v27, v22, v23
    v_lshlrev_b32 v16, 16, v24
    v_and_b32 v17, 0xffff0000, v24
    v_lshlrev_b32 v18, 16, v25
    v_and_b32 v19, 0xffff0000, v25
    v_lshlrev_b32 v20, 16, v26
    v_and_b32 v21, 0xffff0000, v26
    v_lshlrev_b32 v22, 16, v27
    v_and_b32 v23, 0xffff0000, v27
    v_add_f32 v16, v16, v20
    v_add_f32 v17, v17, v21
    v_add_f32 v18, v18, v22
    v_add_f32 v19, v19, v23
    v_add_f32 v16, v16, v18
    v_add_f32 v17, v17, v19
    v_add_f32 v16, v16, v17
    s_nop 1
    v_add_f32_dpp v16, v16, v16 row_ror:1 row_mask:0xf bank_mask:0xf
    s_nop 1
    v_add_f32_dpp v16, v16, v16 row_ror:2 row_mask:0xf bank_mask:0xf
    s_nop 1
    v_add_f32_dpp v16, v16, v16 row_ror:4 row_mask:0xf bank_mask:0xf
    s_nop 1
    v_add_f32_dpp v16, v16, v16 row_ror:8 row_mask:0xf bank_mask:0xf
    v_mov_b32 v17, v16
    s_nop 1
    v_permlane16_swap_b32 v16, v17
    s_nop 1
    v_add_f32 v16, v16, v17
    v_mov_b32 v17, v16
    s_nop 1
    v_permlane32_swap_b32 v16, v17
    s_nop 1
    v_add_f32 v16, v16, v17
    v_cvt_pk_bf16_f32 v16, v16, v16
    s_mov_b32 s63, 0xbfb8aa3b
    v_lshlrev_b32 v16, 16, v16
    v_mul_f32 v16, s63, v16
    v_exp_f32 v16, v16
    s_nop 0
    v_add_f32 v16, 1.0, v16
    v_rcp_f32 v16, v16
    s_nop 0
    v_cvt_pk_bf16_f32 v16, v16, v16
    v_lshlrev_b32 v17, 16, v16
    v_sub_f32 v18, 1.0, v17
    v_cvt_pk_bf16_f32 v18, v18, v18
    v_lshlrev_b32 v18, 16, v18
    ds_write_b32 v12, v17 offset:32
    ds_write_b32 v12, v18 offset:36
    s_movk_i32 s64, 0xff
    s_lshl_b32 s60, s59, 13
    s_add_u32 s62, s60, 4096
    s_lshl_b32 s61, s57, 5
    s_add_u32 s61, s61, s58
    s_lshl_b32 s61, s61, 11
    s_add_u32 s61, s61, 524288
    s_cmp_lt_u32 s58, 28
    s_cselect_b32 s61, s61, s60
    s_mov_b32 s68, 0x400000
L_w1:
    ds_read_b32 v14, v12 offset:64
    s_waitcnt lgkmcnt(0)
    v_readfirstlane_b32 s69, v14
    s_cmp_eq_u32 s69, 4
    s_cbranch_scc1 L_wd1
    s_sleep 1
    s_sub_u32 s68, s68, 1
    s_cmp_lg_u32 s68, 0
    s_cbranch_scc1 L_w1
L_wd1:
    buffer_load_dwordx4 v[16:19], v8, s[44:47], s60 offen offset:0 sc1
    buffer_load_dwordx4 v[20:23], v8, s[44:47], s60 offen offset:1024 sc1
    buffer_load_dwordx4 v[24:27], v8, s[44:47], s60 offen offset:2048 sc1
    buffer_load_dwordx4 v[28:31], v8, s[44:47], s60 offen offset:3072 sc1
    buffer_load_dwordx4 v[32:35], v8, s[44:47], s62 offen offset:0 sc1
    buffer_load_dwordx4 v[36:39], v8, s[44:47], s62 offen offset:1024 sc1
    buffer_load_dwordx4 v[40:43], v8, s[44:47], s62 offen offset:2048 sc1
    buffer_load_dwordx4 v[44:47], v8, s[44:47], s62 offen offset:3072 sc1
    buffer_load_dwordx4 v[48:51], v8, s[44:47], s61 offen offset:0 sc1
    buffer_load_dwordx4 v[52:55], v8, s[44:47], s61 offen offset:1024 sc1
    s_mov_b32 s68, 0x40000
L_p2:
    s_waitcnt vmcnt(0)
    s_mov_b32 s69, 0
    v_msad_u8 v14, v16, s28, 0
    v_msad_u8 v14, v17, s28, v14
    v_msad_u8 v14, v18, s28, v14
    v_msad_u8 v14, v19, s28, v14
    v_cmp_ne_u32 vcc, 0, v14
    s_cbranch_vccz L_pd2_0
    buffer_load_dwordx4 v[16:19], v8, s[44:47], s60 offen offset:0 sc1
    s_mov_b32 s69, 1
L_pd2_0:
    v_msad_u8 v14, v20, s28, 0
    v_msad_u8 v14, v21, s28, v14
    v_msad_u8 v14, v22, s28, v14
    v_msad_u8 v14, v23, s28, v14
    v_cmp_ne_u32 vcc, 0, v14
    s_cbranch_vccz L_pd2_1
    buffer_load_dwordx4 v[20:23], v8, s[44:47], s60 offen offset:1024 sc1
    s_mov_b32 s69, 1
L_pd2_1:
    v_msad_u8 v14, v24, s28, 0
    v_msad_u8 v14, v25, s28, v14
    v_msad_u8 v14, v26, s28, v14
    v_msad_u8 v14, v27, s28, v14
    v_cmp_ne_u32 vcc, 0, v14
    s_cbranch_vccz L_pd2_2
    buffer_load_dwordx4 v[24:27], v8, s[44:47], s60 offen offset:2048 sc1
    s_mov_b32 s69, 1
L_pd2_2:
    v_msad_u8 v14, v28, s28, 0
    v_msad_u8 v14, v29, s28, v14
    v_msad_u8 v14, v30, s28, v14
    v_msad_u8 v14, v31, s28, v14
    v_cmp_ne_u32 vcc, 0, v14
    s_cbranch_vccz L_pd2_3
    buffer_load_dwordx4 v[28:31], v8, s[44:47], s60 offen offset:3072 sc1
    s_mov_b32 s69, 1
L_pd2_3:
    v_msad_u8 v14, v32, s28, 0
    v_msad_u8 v14, v33, s28, v14
    v_msad_u8 v14, v34, s28, v14
    v_msad_u8 v14, v35, s28, v14
    v_cmp_ne_u32 vcc, 0, v14
    s_cbranch_vccz L_pd2_4
    buffer_load_dwordx4 v[32:35], v8, s[44:47], s62 offen offset:0 sc1
    s_mov_b32 s69, 1
L_pd2_4:
    v_msad_u8 v14, v36, s28, 0
    v_msad_u8 v14, v37, s28, v14
    v_msad_u8 v14, v38, s28, v14
    v_msad_u8 v14, v39, s28, v14
    v_cmp_ne_u32 vcc, 0, v14
    s_cbranch_vccz L_pd2_5
    buffer_load_dwordx4 v[36:39], v8, s[44:47], s62 offen offset:1024 sc1
    s_mov_b32 s69, 1
L_pd2_5:
    v_msad_u8 v14, v40, s28, 0
    v_msad_u8 v14, v41, s28, v14
    v_msad_u8 v14, v42, s28, v14
    v_msad_u8 v14, v43, s28, v14
    v_cmp_ne_u32 vcc, 0, v14
    s_cbranch_vccz L_pd2_6
    buffer_load_dwordx4 v[40:43], v8, s[44:47], s62 offen offset:2048 sc1
    s_mov_b32 s69, 1
L_pd2_6:
    v_msad_u8 v14, v44, s28, 0
    v_msad_u8 v14, v45, s28, v14
    v_msad_u8 v14, v46, s28, v14
    v_msad_u8 v14, v47, s28, v14
    v_cmp_ne_u32 vcc, 0, v14
    s_cbranch_vccz L_pd2_7
    buffer_load_dwordx4 v[44:47], v8, s[44:47], s62 offen offset:3072 sc1
    s_mov_b32 s69, 1
L_pd2_7:
    v_msad_u8 v14, v48, s28, 0
    v_msad_u8 v14, v49, s28, v14
    v_msad_u8 v14, v50, s28, v14
    v_msad_u8 v14, v51, s28, v14
    v_cmp_ne_u32 vcc, 0, v14
    s_cbranch_vccz L_pd2_8
    buffer_load_dwordx4 v[48:51], v8, s[44:47], s61 offen offset:0 sc1
    s_mov_b32 s69, 1
L_pd2_8:
    v_msad_u8 v14, v52, s28, 0
    v_msad_u8 v14, v53, s28, v14
    v_msad_u8 v14, v54, s28, v14
    v_msad_u8 v14, v55, s28, v14
    v_cmp_ne_u32 vcc, 0, v14
    s_cbranch_vccz L_pd2_9
    buffer_load_dwordx4 v[52:55], v8, s[44:47], s61 offen offset:1024 sc1
    s_mov_b32 s69, 1
L_pd2_9:
    s_cmp_eq_u32 s69, 0
    s_cbranch_scc1 L_pe2
    s_sub_u32 s68, s68, 1
    s_cmp_lg_u32 s68, 0
    s_cbranch_scc1 L_p2
    s_waitcnt vmcnt(0)
L_pe2:
    s_mov_b32 s69, 0xffffff00
    v_and_b32 v16, s69, v16
    v_and_b32 v17, s69, v17
    v_and_b32 v18, s69, v18
    v_and_b32 v19, s69, v19
    v_and_b32 v20, s69, v20
    v_and_b32 v21, s69, v21
    v_and_b32 v22, s69, v22
    v_and_b32 v23, s69, v23
    v_and_b32 v24, s69, v24
    v_and_b32 v25, s69, v25
    v_and_b32 v26, s69, v26
    v_and_b32 v27, s69, v27
    v_and_b32 v28, s69, v28
    v_and_b32 v29, s69, v29
    v_and_b32 v30, s69, v30
    v_and_b32 v31, s69, v31
    v_and_b32 v32, s69, v32
    v_and_b32 v33, s69, v33
    v_and_b32 v34, s69, v34
    v_and_b32 v35, s69, v35
    v_and_b32 v36, s69, v36
    v_and_b32 v37, s69, v37
    v_and_b32 v38, s69, v38
    v_and_b32 v39, s69, v39
    v_and_b32 v40, s69, v40
    v_and_b32 v41, s69, v41
    v_and_b32 v42, s69, v42
    v_and_b32 v43, s69, v43
    v_and_b32 v44, s69, v44
    v_and_b32 v45, s69, v45
    v_and_b32 v46, s69, v46
    v_and_b32 v47, s69, v47
    v_and_b32 v48, s69, v48
    v_and_b32 v49, s69, v49
    v_and_b32 v50, s69, v50
    v_and_b32 v51, s69, v51
    v_and_b32 v52, s69, v52
    v_and_b32 v53, s69, v53
    v_and_b32 v54, s69, v54
    v_and_b32 v55, s69, v55
    v_add_f32 v16, v16, v24
    v_add_f32 v32, v32, v40
    v_add_f32 v17, v17, v25
    v_add_f32 v33, v33, v41
    v_add_f32 v18, v18, v26
    v_add_f32 v34, v34, v42
    v_add_f32 v19, v19, v27
    v_add_f32 v35, v35, v43
    v_add_f32 v20, v20, v28
    v_add_f32 v36, v36, v44
    v_add_f32 v21, v21, v29
    v_add_f32 v37, v37, v45
    v_add_f32 v22, v22, v30
    v_add_f32 v38, v38, v46
    v_add_f32 v23, v23, v31
    v_add_f32 v39, v39, v47
    v_add_f32 v16, v16, v32
    v_add_f32 v17, v17, v33
    v_add_f32 v18, v18, v34
    v_add_f32 v19, v19, v35
    v_add_f32 v20, v20, v36
    v_add_f32 v21, v21, v37
    v_add_f32 v22, v22, v38
    v_add_f32 v23, v23, v39
    v_cvt_pk_bf16_f32 v24, v16, v17
    v_cvt_pk_bf16_f32 v25, v18, v19
    v_cvt_pk_bf16_f32 v26, v20, v21
    v_cvt_pk_bf16_f32 v27, v22, v23
    v_lshlrev_b32 v10, 3, v0
    ds_write_b64 v10, v[24:25] offset:1024
    ds_write_b64 v10, v[26:27] offset:1536
    ds_write_b32 v12, v13 offset:0
    ds_read_b32 v15, v12 offset:72
    s_cmp_ge_u32 s58, 28
    s_cbranch_scc1 L_C_nohw
    v_add_f32 v48, v48, v52
    v_add_f32 v49, v49, v53
    v_add_f32 v50, v50, v54
    v_add_f32 v51, v51, v55
    v_mov_b32 v52, v48
    v_mov_b32 v53, v49
    v_mov_b32 v54, v50
    v_mov_b32 v55, v51
    s_nop 1
    v_permlane16_swap_b32 v48, v52
    v_permlane16_swap_b32 v49, v53
    v_permlane16_swap_b32 v50, v54
    v_permlane16_swap_b32 v51, v55
    s_nop 1
    v_add_f32 v48, v48, v52
    v_add_f32 v49, v49, v53
    v_add_f32 v50, v50, v54
    v_add_f32 v51, v51, v55
    v_mov_b32 v52, v48
    v_mov_b32 v53, v49
    v_mov_b32 v54, v50
    v_mov_b32 v55, v51
    s_nop 1
    v_permlane32_swap_b32 v48, v52
    v_permlane32_swap_b32 v49, v53
    v_permlane32_swap_b32 v50, v54
    v_permlane32_swap_b32 v51, v55
    s_nop 1
    v_add_f32 v48, v48, v52
    v_add_f32 v49, v49, v53
    v_add_f32 v50, v50, v54
    v_add_f32 v51, v51, v55
    v_cvt_pk_bf16_f32 v52, v48, v49
    v_cvt_pk_bf16_f32 v54, v50, v51
    v_lshlrev_b32 v48, 16, v52
    v_and_b32 v49, 0xffff0000, v52
    v_lshlrev_b32 v50, 16, v54
    v_and_b32 v51, 0xffff0000, v54
    v_mul_f32 v52, s63, v48
    v_mul_f32 v53, s63, v49
    v_mul_f32 v54, s63, v50
    v_mul_f32 v55, s63, v51
    v_exp_f32 v52, v52
    v_exp_f32 v53, v53
    v_exp_f32 v54, v54
    v_exp_f32 v55, v55
    s_nop 0
    v_add_f32 v52, 1.0, v52
    v_add_f32 v53, 1.0, v53
    v_add_f32 v54, 1.0, v54
    v_add_f32 v55, 1.0, v55
    v_rcp_f32 v52, v52
    v_rcp_f32 v53, v53
    v_rcp_f32 v54, v54
    v_rcp_f32 v55, v55
    s_nop 0
    v_mul_f32 v48, v48, v52
    v_mul_f32 v49, v49, v53
    v_mul_f32 v50, v50, v54
    v_mul_f32 v51, v51, v55
    v_cvt_pk_bf16_f32 v52, v48, v49
    v_cvt_pk_bf16_f32 v54, v50, v51
    v_lshlrev_b32 v48, 16, v52
    v_and_b32 v49, 0xffff0000, v52
    v_lshlrev_b32 v50, 16, v54
    v_and_b32 v51, 0xffff0000, v54
    v_bfi_b32 v48, s64, v11, v48
    v_bfi_b32 v49, s64, v11, v49
    v_bfi_b32 v50, s64, v11, v50
    v_bfi_b32 v51, s64, v11, v51
    s_lshl_b32 s61, s58, 3
    s_add_u32 s61, s61, s57
    s_lshl_b32 s61, s61, 8
    s_add_u32 s61, s61, 2097152
    s_waitcnt lgkmcnt(0)
    v_readfirstlane_b32 s65, v15
    s_mov_b64 exec, 0xffff
    s_cmp_eq_u32 s65, 1
    s_cbranch_scc1 L_sf3
    buffer_store_dwordx4 v[48:51], v8, s[44:47], s61 offen sc1
    s_waitcnt vmcnt(0)
    s_branch L_sg3
L_sf3:
    buffer_store_dwordx4 v[48:51], v8, s[44:47], s61 offen
L_sg3:
    s_mov_b64 exec, -1
L_C_nohw:
    v_lshlrev_b32 v11, 3, v0
    s_lshl_b32 s60, s59, 13
    s_add_u32 s60, s60, 1048576
    s_mul_i32 s61, s56, 2240
    s_add_u32 s61, s61, s60
    s_cmp_eq_u32 s56, 3
    s_cselect_b32 s62, 23, 35
    s_lshl_b32 s62, s62, 2
    v_lshlrev_b32 v10, 3, v0
    v_add_u32 v10, 153600, v10
    v_mov_b32 v17, s29
    v_mov_b32 v19, s29
    v_mov_b32 v21, s29
    v_mov_b32 v23, s29
    v_mov_b32 v25, s29
    v_mov_b32 v27, s29
    s_mov_b32 s68, 0x400000
L_w4:
    ds_read_b32 v14, v12 offset:16
    s_waitcnt lgkmcnt(0)
    v_readfirstlane_b32 s69, v14
    s_cmp_eq_u32 s69, 7
    s_cbranch_scc1 L_wd4
    s_sleep 1
    s_sub_u32 s68, s68, 1
    s_cmp_lg_u32 s68, 0
    s_cbranch_scc1 L_w4
L_wd4:
    ds_read_b32 v15, v12 offset:72
    ds_read_b32 v16, v10 offset:0
    ds_read_b32 v18, v10 offset:4
    ds_read_b32 v20, v10 offset:512
    ds_read_b32 v22, v10 offset:516
    ds_read_b32 v24, v10 offset:1024
    ds_read_b32 v26, v10 offset:1028
    s_waitcnt lgkmcnt(0)
    v_readfirstlane_b32 s63, v15
    s_cmp_eq_u32 s63, 1
    s_cbranch_scc1 L_C_sf
    v_cmp_gt_i32 vcc, s62, v0
    s_cbranch_vccz L_C_sp
    s_mov_b64 exec, vcc
    buffer_store_dwordx4 v[16:19], v8, s[44:47], s61 offen offset:0 sc1
    s_mov_b64 exec, -1
    s_sub_u32 s62, s62, 64
    v_cmp_gt_i32 vcc, s62, v0
    s_cbranch_vccz L_C_sp
    s_mov_b64 exec, vcc
    buffer_store_dwordx4 v[20:23], v8, s[44:47], s61 offen offset:1024 sc1
    s_mov_b64 exec, -1
    s_sub_u32 s62, s62, 64
    v_cmp_gt_i32 vcc, s62, v0
    s_cbranch_vccz L_C_sp
    s_mov_b64 exec, vcc
    buffer_store_dwordx4 v[24:27], v8, s[44:47], s61 offen offset:2048 sc1
    s_mov_b64 exec, -1
    s_sub_u32 s62, s62, 64
L_C_sp:
    s_waitcnt vmcnt(0)
    s_branch L_C_sq
L_C_sf:
    v_cmp_gt_i32 vcc, s62, v0
    s_cbranch_vccz L_C_sq
    s_mov_b64 exec, vcc
    buffer_store_dwordx4 v[16:19], v8, s[44:47], s61 offen offset:0
    s_mov_b64 exec, -1
    s_sub_u32 s62, s62, 64
    v_cmp_gt_i32 vcc, s62, v0
    s_cbranch_vccz L_C_sq
    s_mov_b64 exec, vcc
    buffer_store_dwordx4 v[20:23], v8, s[44:47], s61 offen offset:1024
    s_mov_b64 exec, -1
    s_sub_u32 s62, s62, 64
    v_cmp_gt_i32 vcc, s62, v0
    s_cbranch_vccz L_C_sq
    s_mov_b64 exec, vcc
    buffer_store_dwordx4 v[24:27], v8, s[44:47], s61 offen offset:2048
    s_mov_b64 exec, -1
    s_sub_u32 s62, s62, 64
L_C_sq:
    s_nop 1
    s_add_u32 s62, s60, 4096
    buffer_load_dwordx4 v[16:19], v8, s[44:47], s60 offen offset:0 sc1
    buffer_load_dwordx4 v[20:23], v8, s[44:47], s60 offen offset:1024 sc1
    buffer_load_dwordx4 v[24:27], v8, s[44:47], s60 offen offset:2048 sc1
    buffer_load_dwordx4 v[28:31], v8, s[44:47], s60 offen offset:3072 sc1
    buffer_load_dwordx4 v[32:35], v8, s[44:47], s62 offen offset:0 sc1
    buffer_load_dwordx4 v[36:39], v8, s[44:47], s62 offen offset:1024 sc1
    buffer_load_dwordx4 v[40:43], v8, s[44:47], s62 offen offset:2048 sc1
    buffer_load_dwordx4 v[44:47], v8, s[44:47], s62 offen offset:3072 sc1
    s_mov_b32 s68, 0x40000
L_p5:
    s_waitcnt vmcnt(0)
    s_mov_b32 s69, 0
    v_xor_b32 v14, s29, v17
    v_xor_b32 v15, s29, v19
    v_or_b32 v14, v14, v15
    v_cmp_ne_u32 vcc, 0, v14
    s_cbranch_vccz L_pd5_0
    buffer_load_dwordx4 v[16:19], v8, s[44:47], s60 offen offset:0 sc1
    s_mov_b32 s69, 1
L_pd5_0:
    v_xor_b32 v14, s29, v21
    v_xor_b32 v15, s29, v23
    v_or_b32 v14, v14, v15
    v_cmp_ne_u32 vcc, 0, v14
    s_cbranch_vccz L_pd5_1
    buffer_load_dwordx4 v[20:23], v8, s[44:47], s60 offen offset:1024 sc1
    s_mov_b32 s69, 1
L_pd5_1:
    v_xor_b32 v14, s29, v25
    v_xor_b32 v15, s29, v27
    v_or_b32 v14, v14, v15
    v_cmp_ne_u32 vcc, 0, v14
    s_cbranch_vccz L_pd5_2
    buffer_load_dwordx4 v[24:27], v8, s[44:47], s60 offen offset:2048 sc1
    s_mov_b32 s69, 1
L_pd5_2:
    v_xor_b32 v14, s29, v29
    v_xor_b32 v15, s29, v31
    v_or_b32 v14, v14, v15
    v_cmp_ne_u32 vcc, 0, v14
    s_cbranch_vccz L_pd5_3
    buffer_load_dwordx4 v[28:31], v8, s[44:47], s60 offen offset:3072 sc1
    s_mov_b32 s69, 1
L_pd5_3:
    v_xor_b32 v14, s29, v33
    v_xor_b32 v15, s29, v35
    v_or_b32 v14, v14, v15
    v_cmp_ne_u32 vcc, 0, v14
    s_cbranch_vccz L_pd5_4
    buffer_load_dwordx4 v[32:35], v8, s[44:47], s62 offen offset:0 sc1
    s_mov_b32 s69, 1
L_pd5_4:
    v_xor_b32 v14, s29, v37
    v_xor_b32 v15, s29, v39
    v_or_b32 v14, v14, v15
    v_cmp_ne_u32 vcc, 0, v14
    s_cbranch_vccz L_pd5_5
    buffer_load_dwordx4 v[36:39], v8, s[44:47], s62 offen offset:1024 sc1
    s_mov_b32 s69, 1
L_pd5_5:
    v_xor_b32 v14, s29, v41
    v_xor_b32 v15, s29, v43
    v_or_b32 v14, v14, v15
    v_cmp_ne_u32 vcc, 0, v14
    s_cbranch_vccz L_pd5_6
    buffer_load_dwordx4 v[40:43], v8, s[44:47], s62 offen offset:2048 sc1
    s_mov_b32 s69, 1
L_pd5_6:
    v_xor_b32 v14, s29, v45
    v_xor_b32 v15, s29, v47
    v_or_b32 v14, v14, v15
    v_cmp_ne_u32 vcc, 0, v14
    s_cbranch_vccz L_pd5_7
    buffer_load_dwordx4 v[44:47], v8, s[44:47], s62 offen offset:3072 sc1
    s_mov_b32 s69, 1
L_pd5_7:
    s_cmp_eq_u32 s69, 0
    s_cbranch_scc1 L_pe5
    s_sub_u32 s68, s68, 1
    s_cmp_lg_u32 s68, 0
    s_cbranch_scc1 L_p5
    s_waitcnt vmcnt(0)
L_pe5:
    v_lshlrev_b32 v48, 16, v16
    v_and_b32 v56, 0xffff0000, v16
    v_lshlrev_b32 v64, 16, v18
    v_and_b32 v72, 0xffff0000, v18
    v_lshlrev_b32 v49, 16, v20
    v_and_b32 v57, 0xffff0000, v20
    v_lshlrev_b32 v65, 16, v22
    v_and_b32 v73, 0xffff0000, v22
    v_lshlrev_b32 v50, 16, v24
    v_and_b32 v58, 0xffff0000, v24
    v_lshlrev_b32 v66, 16, v26
    v_and_b32 v74, 0xffff0000, v26
    v_lshlrev_b32 v51, 16, v28
    v_and_b32 v59, 0xffff0000, v28
    v_lshlrev_b32 v67, 16, v30
    v_and_b32 v75, 0xffff0000, v30
    v_lshlrev_b32 v52, 16, v32
    v_and_b32 v60, 0xffff0000, v32
    v_lshlrev_b32 v68, 16, v34
    v_and_b32 v76, 0xffff0000, v34
    v_lshlrev_b32 v53, 16, v36
    v_and_b32 v61, 0xffff0000, v36
    v_lshlrev_b32 v69, 16, v38
    v_and_b32 v77, 0xffff0000, v38
    v_lshlrev_b32 v54, 16, v40
    v_and_b32 v62, 0xffff0000, v40
    v_lshlrev_b32 v70, 16, v42
    v_and_b32 v78, 0xffff0000, v42
    v_lshlrev_b32 v55, 16, v44
    v_and_b32 v63, 0xffff0000, v44
    v_lshlrev_b32 v71, 16, v46
    v_and_b32 v79, 0xffff0000, v46
    v_max_f32 v80, v48, v49
    v_max3_f32 v80, v80, v50, v51
    v_max3_f32 v80, v80, v52, v53
    v_max3_f32 v80, v80, v54, v55
    v_max3_f32 v80, v80, v64, v65
    v_max3_f32 v80, v80, v66, v67
    v_max3_f32 v80, v80, v68, v69
    v_max3_f32 v80, v80, v70, v71
    v_max_f32 v81, v56, v57
    v_max3_f32 v81, v81, v58, v59
    v_max3_f32 v81, v81, v60, v61
    v_max3_f32 v81, v81, v62, v63
    v_max3_f32 v81, v81, v72, v73
    v_max3_f32 v81, v81, v74, v75
    v_max3_f32 v81, v81, v76, v77
    v_max3_f32 v81, v81, v78, v79
    s_nop 0
    v_max_f32_dpp v80, v80, v80 row_ror:1 row_mask:0xf bank_mask:0xf
    v_max_f32_dpp v81, v81, v81 row_ror:1 row_mask:0xf bank_mask:0xf
    s_nop 0
    v_max_f32_dpp v80, v80, v80 row_ror:2 row_mask:0xf bank_mask:0xf
    v_max_f32_dpp v81, v81, v81 row_ror:2 row_mask:0xf bank_mask:0xf
    s_nop 0
    v_max_f32_dpp v80, v80, v80 row_ror:4 row_mask:0xf bank_mask:0xf
    v_max_f32_dpp v81, v81, v81 row_ror:4 row_mask:0xf bank_mask:0xf
    s_nop 0
    v_max_f32_dpp v80, v80, v80 row_ror:8 row_mask:0xf bank_mask:0xf
    v_max_f32_dpp v81, v81, v81 row_ror:8 row_mask:0xf bank_mask:0xf
    v_mov_b32 v82, v80
    v_mov_b32 v83, v81
    s_nop 1
    v_permlane16_swap_b32 v80, v82
    v_permlane16_swap_b32 v81, v83
    s_nop 1
    v_max_f32 v80, v80, v82
    v_max_f32 v81, v81, v83
    v_mov_b32 v82, v80
    v_mov_b32 v83, v81
    s_nop 1
    v_permlane32_swap_b32 v80, v82
    v_permlane32_swap_b32 v81, v83
    s_nop 1
    v_max_f32 v80, v80, v82
    v_max_f32 v81, v81, v83
    s_mov_b32 s61, 0x3db8aa3b
    v_mul_f32 v80, s61, v80
    v_mul_f32 v81, s61, v81
    v_fma_f32 v48, v48, s61, -v80
    v_fma_f32 v49, v49, s61, -v80
    v_fma_f32 v50, v50, s61, -v80
    v_fma_f32 v51, v51, s61, -v80
    v_fma_f32 v52, v52, s61, -v80
    v_fma_f32 v53, v53, s61, -v80
    v_fma_f32 v54, v54, s61, -v80
    v_fma_f32 v55, v55, s61, -v80
    v_fma_f32 v56, v56, s61, -v81
    v_fma_f32 v57, v57, s61, -v81
    v_fma_f32 v58, v58, s61, -v81
    v_fma_f32 v59, v59, s61, -v81
    v_fma_f32 v60, v60, s61, -v81
    v_fma_f32 v61, v61, s61, -v81
    v_fma_f32 v62, v62, s61, -v81
    v_fma_f32 v63, v63, s61, -v81
    v_fma_f32 v64, v64, s61, -v80
    v_fma_f32 v65, v65, s61, -v80
    v_fma_f32 v66, v66, s61, -v80
    v_fma_f32 v67, v67, s61, -v80
    v_fma_f32 v68, v68, s61, -v80
    v_fma_f32 v69, v69, s61, -v80
    v_fma_f32 v70, v70, s61, -v80
    v_fma_f32 v71, v71, s61, -v80
    v_fma_f32 v72, v72, s61, -v81
    v_fma_f32 v73, v73, s61, -v81
    v_fma_f32 v74, v74, s61, -v81
    v_fma_f32 v75, v75, s61, -v81
    v_fma_f32 v76, v76, s61, -v81
    v_fma_f32 v77, v77, s61, -v81
    v_fma_f32 v78, v78, s61, -v81
    v_fma_f32 v79, v79, s61, -v81
    v_exp_f32 v48, v48
    v_exp_f32 v49, v49
    v_exp_f32 v50, v50
    v_exp_f32 v51, v51
    v_exp_f32 v52, v52
    v_exp_f32 v53, v53
    v_exp_f32 v54, v54
    v_exp_f32 v55, v55
    v_exp_f32 v56, v56
    v_exp_f32 v57, v57
    v_exp_f32 v58, v58
    v_exp_f32 v59, v59
    v_exp_f32 v60, v60
    v_exp_f32 v61, v61
    v_exp_f32 v62, v62
    v_exp_f32 v63, v63
    v_exp_f32 v64, v64
    v_exp_f32 v65, v65
    v_exp_f32 v66, v66
    v_exp_f32 v67, v67
    v_exp_f32 v68, v68
    v_exp_f32 v69, v69
    v_exp_f32 v70, v70
    v_exp_f32 v71, v71
    v_exp_f32 v72, v72
    v_exp_f32 v73, v73
    v_exp_f32 v74, v74
    v_exp_f32 v75, v75
    v_exp_f32 v76, v76
    v_exp_f32 v77, v77
    v_exp_f32 v78, v78
    v_exp_f32 v79, v79
    s_nop 0
    v_add_f32 v80, v48, v49
    v_add_f32 v82, v50, v51
    v_add_f32 v81, v56, v57
    v_add_f32 v83, v58, v59
    v_add_f32 v80, v80, v52
    v_add_f32 v82, v82, v53
    v_add_f32 v81, v81, v60
    v_add_f32 v83, v83, v61
    v_add_f32 v80, v80, v54
    v_add_f32 v82, v82, v55
    v_add_f32 v81, v81, v62
    v_add_f32 v83, v83, v63
    v_add_f32 v80, v80, v64
    v_add_f32 v82, v82, v65
    v_add_f32 v81, v81, v72
    v_add_f32 v83, v83, v73
    v_add_f32 v80, v80, v66
    v_add_f32 v82, v82, v67
    v_add_f32 v81, v81, v74
    v_add_f32 v83, v83, v75
    v_add_f32 v80, v80, v68
    v_add_f32 v82, v82, v69
    v_add_f32 v81, v81, v76
    v_add_f32 v83, v83, v77
    v_add_f32 v80, v80, v70
    v_add_f32 v82, v82, v71
    v_add_f32 v81, v81, v78
    v_add_f32 v83, v83, v79
    v_add_f32 v80, v80, v82
    v_add_f32 v81, v81, v83
    s_nop 0
    v_add_f32_dpp v80, v80, v80 row_ror:1 row_mask:0xf bank_mask:0xf
    v_add_f32_dpp v81, v81, v81 row_ror:1 row_mask:0xf bank_mask:0xf
    s_nop 0
    v_add_f32_dpp v80, v80, v80 row_ror:2 row_mask:0xf bank_mask:0xf
    v_add_f32_dpp v81, v81, v81 row_ror:2 row_mask:0xf bank_mask:0xf
    s_nop 0
    v_add_f32_dpp v80, v80, v80 row_ror:4 row_mask:0xf bank_mask:0xf
    v_add_f32_dpp v81, v81, v81 row_ror:4 row_mask:0xf bank_mask:0xf
    s_nop 0
    v_add_f32_dpp v80, v80, v80 row_ror:8 row_mask:0xf bank_mask:0xf
    v_add_f32_dpp v81, v81, v81 row_ror:8 row_mask:0xf bank_mask:0xf
    v_mov_b32 v82, v80
    v_mov_b32 v83, v81
    s_nop 1
    v_permlane16_swap_b32 v80, v82
    v_permlane16_swap_b32 v81, v83
    s_nop 1
    v_add_f32 v80, v80, v82
    v_add_f32 v81, v81, v83
    v_mov_b32 v82, v80
    v_mov_b32 v83, v81
    s_nop 1
    v_permlane32_swap_b32 v80, v82
    v_permlane32_swap_b32 v81, v83
    s_nop 1
    v_add_f32 v80, v80, v82
    v_add_f32 v81, v81, v83
    v_rcp_f32 v80, v80
    v_rcp_f32 v81, v81
    s_nop 0
    v_mul_f32 v48, v80, v48
    v_mul_f32 v49, v80, v49
    v_mul_f32 v50, v80, v50
    v_mul_f32 v51, v80, v51
    v_mul_f32 v52, v80, v52
    v_mul_f32 v53, v80, v53
    v_mul_f32 v54, v80, v54
    v_mul_f32 v55, v80, v55
    v_mul_f32 v56, v81, v56
    v_mul_f32 v57, v81, v57
    v_mul_f32 v58, v81, v58
    v_mul_f32 v59, v81, v59
    v_mul_f32 v60, v81, v60
    v_mul_f32 v61, v81, v61
    v_mul_f32 v62, v81, v62
    v_mul_f32 v63, v81, v63
    v_mul_f32 v64, v80, v64
    v_mul_f32 v65, v80, v65
    v_mul_f32 v66, v80, v66
    v_mul_f32 v67, v80, v67
    v_mul_f32 v68, v80, v68
    v_mul_f32 v69, v80, v69
    v_mul_f32 v70, v80, v70
    v_mul_f32 v71, v80, v71
    v_mul_f32 v72, v81, v72
    v_mul_f32 v73, v81, v73
    v_mul_f32 v74, v81, v74
    v_mul_f32 v75, v81, v75
    v_mul_f32 v76, v81, v76
    v_mul_f32 v77, v81, v77
    v_mul_f32 v78, v81, v78
    v_mul_f32 v79, v81, v79
    v_cvt_pk_bf16_f32 v84, v48, v56
    v_cvt_pk_bf16_f32 v85, v64, v72
    ds_write_b64 v11, v[84:85] offset:2048
    v_cvt_pk_bf16_f32 v86, v49, v57
    v_cvt_pk_bf16_f32 v87, v65, v73
    ds_write_b64 v11, v[86:87] offset:2560
    v_cvt_pk_bf16_f32 v88, v50, v58
    v_cvt_pk_bf16_f32 v89, v66, v74
    ds_write_b64 v11, v[88:89] offset:3072
    v_cvt_pk_bf16_f32 v90, v51, v59
    v_cvt_pk_bf16_f32 v91, v67, v75
    ds_write_b64 v11, v[90:91] offset:3584
    v_cvt_pk_bf16_f32 v92, v52, v60
    v_cvt_pk_bf16_f32 v93, v68, v76
    ds_write_b64 v11, v[92:93] offset:4096
    v_cvt_pk_bf16_f32 v94, v53, v61
    v_cvt_pk_bf16_f32 v95, v69, v77
    ds_write_b64 v11, v[94:95] offset:4608
    v_cvt_pk_bf16_f32 v96, v54, v62
    v_cvt_pk_bf16_f32 v97, v70, v78
    ds_write_b64 v11, v[96:97] offset:5120
    v_cvt_pk_bf16_f32 v98, v55, v63
    v_cvt_pk_bf16_f32 v99, v71, v79
    ds_write_b64 v11, v[98:99] offset:5632
    ds_write_b32 v12, v13 offset:8
    s_cmp_ge_u32 s58, 14
    s_cbranch_scc1 L_C_done
    s_lshl_b32 s60, s57, 4
    s_add_u32 s60, s60, s58
    s_lshl_b32 s60, s60, 12
    s_add_u32 s60, s60, 1572864
    s_mul_i32 s61, s57, 896
    s_lshl_b32 s62, s58, 6
    s_add_u32 s61, s61, s62
    v_lshlrev_b32 v9, 3, v0
    s_mov_b32 s68, 0x400000
L_w6:
    ds_read_b32 v14, v12 offset:24
    s_waitcnt lgkmcnt(0)
    v_readfirstlane_b32 s69, v14
    s_cmp_eq_u32 s69, 7
    s_cbranch_scc1 L_wd6
    s_sleep 1
    s_sub_u32 s68, s68, 1
    s_cmp_lg_u32 s68, 0
    s_cbranch_scc1 L_w6
L_wd6:
    buffer_load_dwordx4 v[48:51], v8, s[44:47], s60 offen offset:0 sc1
    buffer_load_dwordx4 v[52:55], v8, s[44:47], s60 offen offset:1024 sc1
    buffer_load_dwordx4 v[56:59], v8, s[44:47], s60 offen offset:2048 sc1
    buffer_load_dwordx4 v[60:63], v8, s[44:47], s60 offen offset:3072 sc1
    s_mov_b32 s68, 0x10000
    s_mov_b32 s69, 0xffffff00
L_fp:
    s_waitcnt vmcnt(0)
    v_msad_u8 v14, v48, s28, 0
    v_msad_u8 v14, v49, s28, v14
    v_msad_u8 v14, v50, s28, v14
    v_msad_u8 v14, v51, s28, v14
    v_msad_u8 v14, v52, s28, v14
    v_msad_u8 v14, v53, s28, v14
    v_msad_u8 v14, v54, s28, v14
    v_msad_u8 v14, v55, s28, v14
    v_msad_u8 v14, v56, s28, v14
    v_msad_u8 v14, v57, s28, v14
    v_msad_u8 v14, v58, s28, v14
    v_msad_u8 v14, v59, s28, v14
    v_msad_u8 v14, v60, s28, v14
    v_msad_u8 v14, v61, s28, v14
    v_msad_u8 v14, v62, s28, v14
    v_msad_u8 v14, v63, s28, v14
    v_and_b32 v48, s69, v48
    v_and_b32 v49, s69, v49
    v_and_b32 v50, s69, v50
    v_and_b32 v51, s69, v51
    v_and_b32 v52, s69, v52
    v_and_b32 v53, s69, v53
    v_and_b32 v54, s69, v54
    v_and_b32 v55, s69, v55
    v_and_b32 v56, s69, v56
    v_and_b32 v57, s69, v57
    v_and_b32 v58, s69, v58
    v_and_b32 v59, s69, v59
    v_and_b32 v60, s69, v60
    v_and_b32 v61, s69, v61
    v_and_b32 v62, s69, v62
    v_and_b32 v63, s69, v63
    v_add_f32 v16, v48, v52
    v_add_f32 v17, v49, v53
    v_add_f32 v18, v50, v54
    v_add_f32 v19, v51, v55
    v_add_f32 v20, v56, v60
    v_add_f32 v21, v57, v61
    v_add_f32 v22, v58, v62
    v_add_f32 v23, v59, v63
    v_cmp_ne_u32 vcc, 0, v14
    s_cbranch_vccz L_fd
    buffer_load_dwordx4 v[48:51], v8, s[44:47], s60 offen offset:0 sc1
    buffer_load_dwordx4 v[52:55], v8, s[44:47], s60 offen offset:1024 sc1
    buffer_load_dwordx4 v[56:59], v8, s[44:47], s60 offen offset:2048 sc1
    buffer_load_dwordx4 v[60:63], v8, s[44:47], s60 offen offset:3072 sc1
    s_sub_u32 s68, s68, 1
    s_cmp_lg_u32 s68, 0
    s_cbranch_scc1 L_fp
L_fd:
    v_add_f32 v16, v16, v20
    v_add_f32 v17, v17, v21
    v_add_f32 v18, v18, v22
    v_add_f32 v19, v19, v23
    v_add_f32_dpp v16, v16, v16 row_ror:8 row_mask:0xf bank_mask:0xf
    v_add_f32_dpp v17, v17, v17 row_ror:8 row_mask:0xf bank_mask:0xf
    v_add_f32_dpp v18, v18, v18 row_ror:8 row_mask:0xf bank_mask:0xf
    v_add_f32_dpp v19, v19, v19 row_ror:8 row_mask:0xf bank_mask:0xf
    v_mov_b32 v20, v16
    v_mov_b32 v21, v17
    v_mov_b32 v22, v18
    v_mov_b32 v23, v19
    s_nop 0
    v_permlane16_swap_b32 v16, v20
    v_permlane16_swap_b32 v17, v21
    v_permlane16_swap_b32 v18, v22
    v_permlane16_swap_b32 v19, v23
    v_add_f32 v16, v16, v20
    v_add_f32 v17, v17, v21
    v_add_f32 v18, v18, v22
    v_add_f32 v19, v19, v23
    v_mov_b32 v20, v16
    v_mov_b32 v21, v17
    v_mov_b32 v22, v18
    v_mov_b32 v23, v19
    s_nop 0
    v_permlane32_swap_b32 v16, v20
    v_permlane32_swap_b32 v17, v21
    v_permlane32_swap_b32 v18, v22
    v_permlane32_swap_b32 v19, v23
    v_add_f32 v16, v16, v20
    v_add_f32 v17, v17, v21
    v_add_f32 v18, v18, v22
    v_add_f32 v19, v19, v23
    v_cvt_pk_bf16_f32 v20, v16, v17
    v_cvt_pk_bf16_f32 v21, v18, v19
    s_mov_b64 exec, 0xff
    buffer_store_dwordx2 v[20:21], v9, s[52:55], s61 offen
    s_or_b32 s62, s57, s58
    s_cmp_lg_u32 s62, 0
    s_cbranch_scc1 L_C_done
    s_mov_b64 exec, 1
    v_mov_b32 v41, s29
    s_mov_b32 s62, 581632
    buffer_store_dword v41, v12, s[44:47], s62 offen
L_C_done:
L_exit:
    s_endpgm
L_S:
    s_sub_u32 s60, s3, 1
    v_and_b32 v4, 7, v3
    v_lshlrev_b32 v4, 9, v4
    v_lshrrev_b32 v5, 3, v3
    v_cmp_eq_u32 s[54:55], 1, v5
    v_lshl_add_u32 v5, v5, 2, v2
    v_lshl_add_u32 v4, v5, 4, v4
    s_lshl_b32 s66, s60, 7
    v_lshrrev_b32 v6, 2, v3
    v_lshl_add_u32 v1, v2, 3, v6
    v_and_b32 v7, 3, v3
    v_lshlrev_b32 v7, 3, v7
    v_mul_u32_u24 v1, 896, v1
    v_add3_u32 v6, v1, v7, s66
    v_add_u32 v6, 32768, v6
    v_and_b32 v7, 1, v3
    v_lshlrev_b32 v7, 9, v7
    v_bfe_u32 v1, v3, 1, 1
    v_lshl_add_u32 v7, v1, 6, v7
    v_lshl_add_u32 v7, v2, 4, v7
    v_lshlrev_b32 v8, 4, v2
    v_mov_b32 v10, 0
    v_mov_b32 v11, 1
    v_cmp_eq_u32 s[48:49], 1, v2
    v_cmp_eq_u32 s[50:51], 2, v2
    v_cmp_eq_u32 s[52:53], 3, v2
    s_cmp_eq_u32 s56, 3
    s_cselect_b32 s62, 3, 5
    s_cselect_b32 s63, 2, 0
    s_cmp_lt_u32 s60, s63
    s_cselect_b32 s64, 1, 0
    s_add_u32 s64, s64, s62
    s_mul_i32 s65, s60, s62
    s_min_u32 s63, s60, s63
    s_add_u32 s65, s65, s63
    s_mul_i32 s63, s56, 35
    s_add_u32 s65, s65, s63
    s_waitcnt lgkmcnt(0)
    s_mov_b32 s32, s6
    s_mov_b32 s33, s7
    s_mov_b32 s34, 134217728
    s_mov_b32 s35, 0x20000
    s_mov_b32 s44, s26
    s_mov_b32 s45, s27
    s_mov_b32 s46, 2883584
    s_mov_b32 s47, 0x20000
    s_mov_b32 s40, s12
    s_mov_b32 s41, s13
    s_mov_b32 s42, 3670016
    s_mov_b32 s43, 0x20000
    s_lshl_b32 s36, s30, 9
    s_lshl_b32 s37, s56, 6
    s_add_u32 s36, s36, s37
    s_mul_i32 s36, s36, 896
    s_mul_i32 s67, s60, 4096
    s_add_u32 s36, s36, s67
    s_add_u32 s37, s67, 90112
    v_lshlrev_b32 v9, 4, v0
    s_lshl_b32 s62, s59, 21
    s_add_u32 s62, s62, 0x180000
    s_lshl_b32 s63, s65, 12
    s_add_u32 s62, s62, s63
    s_cmp_lg_u32 s60, 6
    s_cbranch_scc1 L_S_nx
    s_load_dword s29, s[26:27], 581632
    s_getreg_b32 s63, hwreg(HW_REG_XCC_ID, 0, 4)
    v_and_b32 v12, 31, v0
    v_lshlrev_b32 v12, 2, v12
    s_lshl_b32 s38, s30, 7
    s_add_u32 s38, s38, 583680
    s_lshl_b32 s39, s31, 2
    s_add_u32 s39, s39, s38
    s_waitcnt lgkmcnt(0)
    s_add_u32 s29, s29, 1
    s_and_b32 s28, s29, 0xff
    s_cselect_b32 s28, 0, 1
    s_add_u32 s29, s29, s28
    s_mul_i32 s29, s29, 0x9e3779b1
    s_and_b32 s29, s29, -16
    s_or_b32 s63, s63, s29
    v_mov_b32 v13, s63
    s_mov_b64 exec, 1
    buffer_store_dword v13, v10, s[44:47], s39 offen sc1
    s_mov_b64 exec, -1
    s_mov_b32 s68, 0x40000
L_S_xp:
    buffer_load_dword v14, v12, s[44:47], s38 offen sc1
    s_waitcnt vmcnt(0)
    v_and_b32 v15, -16, v14
    v_cmp_ne_u32 vcc, s29, v15
    s_cbranch_vccz L_S_xd
    s_sub_u32 s68, s68, 1
    s_cmp_lg_u32 s68, 0
    s_cbranch_scc1 L_S_xp
L_S_xd:
    v_cmp_ne_u32 vcc, s63, v14
    s_cmp_eq_u64 vcc, 0
    s_cselect_b32 s63, 1, 2
    v_mov_b32 v13, s63
    ds_write_b32 v10, v13 offset:72
L_S_nx:
    s_mov_b32 s68, 0x400000
L_w7:
    ds_read_b32 v1, v10 offset:12
    s_waitcnt lgkmcnt(0)
    v_readfirstlane_b32 s69, v1
    s_cmp_eq_u32 s69, s3
    s_cbranch_scc1 L_wd7
    s_sleep 1
    s_sub_u32 s68, s68, 1
    s_cmp_lg_u32 s68, 0
    s_cbranch_scc1 L_w7
L_wd7:
    s_setprio 2
    s_mov_b32 m0, s37
    buffer_load_dwordx4 v[12:15], v4, s[32:35], s62 offen offset:0 nt
    buffer_load_dwordx4 v9, s[40:43], s36 offen offset:0 nt lds
    buffer_load_dwordx4 v[16:19], v4, s[32:35], s62 offen offset:128 nt
    buffer_load_dwordx4 v[20:23], v4, s[32:35], s62 offen offset:256 nt
    buffer_load_dwordx4 v[24:27], v4, s[32:35], s62 offen offset:384 nt
    buffer_load_dwordx4 v9, s[40:43], s36 offen offset:1024 nt lds
    s_add_u32 s62, s62, 4096
    buffer_load_dwordx4 v[28:31], v4, s[32:35], s62 offen offset:0 nt
    buffer_load_dwordx4 v[32:35], v4, s[32:35], s62 offen offset:128 nt
    buffer_load_dwordx4 v[36:39], v4, s[32:35], s62 offen offset:256 nt
    buffer_load_dwordx4 v9, s[40:43], s36 offen offset:2048 nt lds
    buffer_load_dwordx4 v[40:43], v4, s[32:35], s62 offen offset:384 nt
    s_add_u32 s62, s62, 4096
    s_cmp_lg_u32 s64, 3
    s_cbranch_scc1 L_S_nt2
    s_mov_b64 exec, 1
    ds_add_u32 v10, v11 offset:12
    s_mov_b64 exec, -1
L_S_nt2:
    buffer_load_dwordx4 v[44:47], v4, s[32:35], s62 offen offset:0 nt
    buffer_load_dwordx4 v[48:51], v4, s[32:35], s62 offen offset:128 nt
    buffer_load_dwordx4 v9, s[40:43], s36 offen offset:3072 nt lds
    s_add_u32 s36, s36, 4096
    s_add_u32 s37, s37, 4096
    buffer_load_dwordx4 v[52:55], v4, s[32:35], s62 offen offset:256 nt
    buffer_load_dwordx4 v[56:59], v4, s[32:35], s62 offen offset:384 nt
    s_add_u32 s62, s62, 4096
    s_cmp_le_u32 s64, 3
    s_cbranch_scc1 L_S_kd
    s_cmp_lg_u32 s64, 4
    s_cbranch_scc1 L_S_nt3
    s_mov_b64 exec, 1
    ds_add_u32 v10, v11 offset:12
    s_mov_b64 exec, -1
L_S_nt3:
    buffer_load_dwordx4 v[60:63], v4, s[32:35], s62 offen offset:0 nt
    buffer_load_dwordx4 v[64:67], v4, s[32:35], s62 offen offset:128 nt
    buffer_load_dwordx4 v[68:71], v4, s[32:35], s62 offen offset:256 nt
    buffer_load_dwordx4 v[72:75], v4, s[32:35], s62 offen offset:384 nt
    s_add_u32 s62, s62, 4096
    s_cmp_le_u32 s64, 4
    s_cbranch_scc1 L_S_kd
    s_cmp_lg_u32 s64, 5
    s_cbranch_scc1 L_S_nt4
    s_mov_b64 exec, 1
    ds_add_u32 v10, v11 offset:12
    s_mov_b64 exec, -1
L_S_nt4:
    buffer_load_dwordx4 v[76:79], v4, s[32:35], s62 offen offset:0 nt
    buffer_load_dwordx4 v[80:83], v4, s[32:35], s62 offen offset:128 nt
    buffer_load_dwordx4 v[84:87], v4, s[32:35], s62 offen offset:256 nt
    buffer_load_dwordx4 v[88:91], v4, s[32:35], s62 offen offset:384 nt
L_S_kd:
    s_setprio 0
    s_mul_i32 s63, s56, 35
    s_sub_u32 s63, s65, s63
    s_lshl_b32 s63, s63, 5
    s_add_u32 s63, s63, 153600
    v_lshl_add_u32 v5, v0, 2, s63
    s_lshl_b32 s63, s64, 3
    s_lshl_b64 s[38:39], 1, s63
    s_sub_u32 s38, s38, 1
    s_subb_u32 s39, s39, 0
    s_waitcnt vmcnt(0)
    s_mov_b64 exec, 1
    ds_add_u32 v10, v11 offset:48
    s_mov_b64 exec, -1
    s_mov_b32 s68, 0x400000
L_w8:
    ds_read_b32 v1, v10 offset:0
    s_waitcnt lgkmcnt(0)
    v_readfirstlane_b32 s69, v1
    s_cmp_eq_u32 s69, 1
    s_cbranch_scc1 L_wd8
    s_sleep 1
    s_sub_u32 s68, s68, 1
    s_cmp_lg_u32 s68, 0
    s_cbranch_scc1 L_w8
L_wd8:
    ds_read_b32 v1, v10 offset:28
    ds_read_b128 v[92:95], v7 offset:1024
    ds_read_b128 v[96:99], v7 offset:1152
    ds_read_b128 v[100:103], v7 offset:1280
    ds_read_b128 v[104:107], v7 offset:1408
    s_waitcnt vmcnt(0) lgkmcnt(0)
    v_readfirstlane_b32 s29, v1
    v_mfma_f32_16x16x32_bf16 v[140:143], v[92:95], v[12:15], 0
    v_mfma_f32_16x16x32_bf16 v[140:143], v[96:99], v[16:19], v[140:143]
    v_mfma_f32_16x16x32_bf16 v[140:143], v[100:103], v[20:23], v[140:143]
    v_mfma_f32_16x16x32_bf16 v[140:143], v[104:107], v[24:27], v[140:143]
    v_mfma_f32_16x16x32_bf16 v[144:147], v[92:95], v[28:31], 0
    v_mfma_f32_16x16x32_bf16 v[144:147], v[96:99], v[32:35], v[144:147]
    v_mfma_f32_16x16x32_bf16 v[144:147], v[100:103], v[36:39], v[144:147]
    v_mfma_f32_16x16x32_bf16 v[144:147], v[104:107], v[40:43], v[144:147]
    v_mfma_f32_16x16x32_bf16 v[148:151], v[92:95], v[44:47], 0
    v_mfma_f32_16x16x32_bf16 v[148:151], v[96:99], v[48:51], v[148:151]
    v_mfma_f32_16x16x32_bf16 v[148:151], v[100:103], v[52:55], v[148:151]
    v_mfma_f32_16x16x32_bf16 v[148:151], v[104:107], v[56:59], v[148:151]
    s_cmp_le_u32 s64, 3
    s_cbranch_scc1 L_S_qd
    v_mfma_f32_16x16x32_bf16 v[152:155], v[92:95], v[60:63], 0
    v_mfma_f32_16x16x32_bf16 v[152:155], v[96:99], v[64:67], v[152:155]
    v_mfma_f32_16x16x32_bf16 v[152:155], v[100:103], v[68:71], v[152:155]
    v_mfma_f32_16x16x32_bf16 v[152:155], v[104:107], v[72:75], v[152:155]
    s_cmp_le_u32 s64, 4
    s_cbranch_scc1 L_S_qd
    v_mfma_f32_16x16x32_bf16 v[156:159], v[92:95], v[76:79], 0
    v_mfma_f32_16x16x32_bf16 v[156:159], v[96:99], v[80:83], v[156:159]
    v_mfma_f32_16x16x32_bf16 v[156:159], v[100:103], v[84:87], v[156:159]
    v_mfma_f32_16x16x32_bf16 v[156:159], v[104:107], v[88:91], v[156:159]
L_S_qd:
    s_nop 7
    v_cndmask_b32 v140, v140, v142, s[54:55]
    v_cndmask_b32 v141, v141, v143, s[54:55]
    v_cndmask_b32 v144, v144, v146, s[54:55]
    v_cndmask_b32 v145, v145, v147, s[54:55]
    v_cndmask_b32 v148, v148, v150, s[54:55]
    v_cndmask_b32 v149, v149, v151, s[54:55]
    v_cndmask_b32 v152, v152, v154, s[54:55]
    v_cndmask_b32 v153, v153, v155, s[54:55]
    v_cndmask_b32 v156, v156, v158, s[54:55]
    v_cndmask_b32 v157, v157, v159, s[54:55]
    v_add_f32_dpp v140, v140, v140 row_ror:8 row_mask:0xf bank_mask:0xf
    v_add_f32_dpp v141, v141, v141 row_ror:8 row_mask:0xf bank_mask:0xf
    v_add_f32_dpp v144, v144, v144 row_ror:8 row_mask:0xf bank_mask:0xf
    v_add_f32_dpp v145, v145, v145 row_ror:8 row_mask:0xf bank_mask:0xf
    v_add_f32_dpp v148, v148, v148 row_ror:8 row_mask:0xf bank_mask:0xf
    v_add_f32_dpp v149, v149, v149 row_ror:8 row_mask:0xf bank_mask:0xf
    v_add_f32_dpp v152, v152, v152 row_ror:8 row_mask:0xf bank_mask:0xf
    v_add_f32_dpp v153, v153, v153 row_ror:8 row_mask:0xf bank_mask:0xf
    v_add_f32_dpp v156, v156, v156 row_ror:8 row_mask:0xf bank_mask:0xf
    v_add_f32_dpp v157, v157, v157 row_ror:8 row_mask:0xf bank_mask:0xf
    v_cvt_pk_bf16_f32 v160, v140, v141
    s_mov_b32 exec_lo, 0xff00
    s_mov_b32 exec_hi, 0x0
    v_cvt_pk_bf16_f32 v160, v144, v145
    s_mov_b32 exec_lo, 0xff0000
    s_mov_b32 exec_hi, 0x0
    v_cvt_pk_bf16_f32 v160, v148, v149
    s_mov_b32 exec_lo, 0xff000000
    s_mov_b32 exec_hi, 0x0
    v_cvt_pk_bf16_f32 v160, v152, v153
    s_mov_b32 exec_lo, 0x0
    s_mov_b32 exec_hi, 0xff
    v_cvt_pk_bf16_f32 v160, v156, v157
    s_mov_b64 exec, s[38:39]
    ds_write_b32 v5, v160
    s_mov_b64 exec, 1
    ds_add_u32 v10, v11 offset:16
    s_mov_b64 exec, -1
    s_and_b32 s28, s29, 0xff
    s_movk_i32 s64, 0xff
    v_mov_b32 v7, s29
    v_mov_b32 v84, 0
    s_cmp_ge_u32 s58, 28
    s_cbranch_scc1 L_S_nof
    s_cmp_ge_u32 s60, 2
    s_cbranch_scc1 L_S_nt
    s_cmp_ge_u32 s57, 7
    s_cbranch_scc1 L_S_nt
    v_lshrrev_b32 v4, 2, v3
    v_lshl_add_u32 v4, v2, 3, v4
    v_and_b32 v5, 3, v3
    v_lshlrev_b32 v5, 3, v5
    v_lshl_add_u32 v4, v4, 7, v5
    s_lshl_b32 s63, s60, 6
    s_add_u32 s63, s63, 155136
    v_add_u32 v4, s63, v4
    v_and_b32 v12, 7, v3
    v_lshlrev_b32 v5, 5, v2
    v_lshl_add_u32 v5, v12, 8, v5
    v_lshrrev_b32 v13, 3, v3
    v_lshl_add_u32 v13, v13, 6, v8
    v_lshl_add_u32 v13, v12, 11, v13
    s_lshl_b32 s61, s58, 11
    s_add_u32 s61, s61, 2097152
    s_lshl_b32 s62, s58, 14
    s_lshl_b32 s63, s57, 8
    s_add_u32 s62, s62, s63
    s_add_u32 s62, s62, s66
    s_add_u32 s62, s62, 2359296
    s_mov_b32 s68, 0x400000
L_w9:
    ds_read_b32 v1, v10 offset:76
    s_waitcnt lgkmcnt(0)
    v_readfirstlane_b32 s69, v1
    s_cmp_eq_u32 s69, 1
    s_cbranch_scc1 L_wd9
    s_sleep 1
    s_sub_u32 s68, s68, 1
    s_cmp_lg_u32 s68, 0
    s_cbranch_scc1 L_w9
L_wd9:
    ds_read_b32 v14, v10 offset:72
    ds_read_b64_tr_b16 v[20:21], v4 offset:0
    ds_read_b64_tr_b16 v[22:23], v4 offset:512
    ds_read_b64_tr_b16 v[24:25], v4 offset:32
    ds_read_b64_tr_b16 v[26:27], v4 offset:544
    ds_read_b64_tr_b16 v[28:29], v4 offset:4096
    ds_read_b64_tr_b16 v[30:31], v4 offset:4608
    ds_read_b64_tr_b16 v[32:33], v4 offset:4128
    ds_read_b64_tr_b16 v[34:35], v4 offset:4640
    buffer_load_dwordx4 v[52:55], v5, s[44:47], s61 offen offset:0 sc1
    buffer_load_dwordx4 v[56:59], v5, s[44:47], s61 offen offset:16 sc1
    buffer_load_dwordx4 v[60:63], v5, s[44:47], s61 offen offset:128 sc1
    buffer_load_dwordx4 v[64:67], v5, s[44:47], s61 offen offset:144 sc1
    s_mov_b32 s68, 0x40000
L_p10:
    s_waitcnt vmcnt(0)
    s_mov_b32 s69, 0
    v_msad_u8 v1, v52, s28, 0
    v_msad_u8 v1, v53, s28, v1
    v_msad_u8 v1, v54, s28, v1
    v_msad_u8 v1, v55, s28, v1
    v_cmp_ne_u32 vcc, 0, v1
    s_cbranch_vccz L_pd10_0
    buffer_load_dwordx4 v[52:55], v5, s[44:47], s61 offen offset:0 sc1
    s_mov_b32 s69, 1
L_pd10_0:
    v_msad_u8 v1, v56, s28, 0
    v_msad_u8 v1, v57, s28, v1
    v_msad_u8 v1, v58, s28, v1
    v_msad_u8 v1, v59, s28, v1
    v_cmp_ne_u32 vcc, 0, v1
    s_cbranch_vccz L_pd10_1
    buffer_load_dwordx4 v[56:59], v5, s[44:47], s61 offen offset:16 sc1
    s_mov_b32 s69, 1
L_pd10_1:
    v_msad_u8 v1, v60, s28, 0
    v_msad_u8 v1, v61, s28, v1
    v_msad_u8 v1, v62, s28, v1
    v_msad_u8 v1, v63, s28, v1
    v_cmp_ne_u32 vcc, 0, v1
    s_cbranch_vccz L_pd10_2
    buffer_load_dwordx4 v[60:63], v5, s[44:47], s61 offen offset:128 sc1
    s_mov_b32 s69, 1
L_pd10_2:
    v_msad_u8 v1, v64, s28, 0
    v_msad_u8 v1, v65, s28, v1
    v_msad_u8 v1, v66, s28, v1
    v_msad_u8 v1, v67, s28, v1
    v_cmp_ne_u32 vcc, 0, v1
    s_cbranch_vccz L_pd10_3
    buffer_load_dwordx4 v[64:67], v5, s[44:47], s61 offen offset:144 sc1
    s_mov_b32 s69, 1
L_pd10_3:
    s_cmp_eq_u32 s69, 0
    s_cbranch_scc1 L_pe10
    s_sub_u32 s68, s68, 1
    s_cmp_lg_u32 s68, 0
    s_cbranch_scc1 L_p10
    s_waitcnt vmcnt(0)
L_pe10:
    v_cvt_pk_bf16_f32 v68, v52, v53
    v_cvt_pk_bf16_f32 v69, v54, v55
    v_cvt_pk_bf16_f32 v70, v56, v57
    v_cvt_pk_bf16_f32 v71, v58, v59
    v_cvt_pk_bf16_f32 v72, v60, v61
    v_cvt_pk_bf16_f32 v73, v62, v63
    v_cvt_pk_bf16_f32 v74, v64, v65
    v_cvt_pk_bf16_f32 v75, v66, v67
    s_waitcnt lgkmcnt(0)
    v_readfirstlane_b32 s65, v14
    v_mfma_f32_16x16x32_bf16 v[36:39], v[20:23], v[68:71], 0
    v_mfma_f32_16x16x32_bf16 v[40:43], v[24:27], v[68:71], 0
    v_mfma_f32_16x16x32_bf16 v[36:39], v[28:31], v[72:75], v[36:39]
    v_mfma_f32_16x16x32_bf16 v[40:43], v[32:35], v[72:75], v[40:43]
    s_nop 7
    v_cndmask_b32 v36, v36, v40, s[54:55]
    v_cndmask_b32 v37, v37, v41, s[54:55]
    v_cndmask_b32 v38, v38, v42, s[54:55]
    v_cndmask_b32 v39, v39, v43, s[54:55]
    v_add_u32 v36, 0x80, v36
    v_add_u32 v37, 0x80, v37
    v_add_u32 v38, 0x80, v38
    v_add_u32 v39, 0x80, v39
    v_bfi_b32 v36, s64, v7, v36
    v_bfi_b32 v37, s64, v7, v37
    v_bfi_b32 v38, s64, v7, v38
    v_bfi_b32 v39, s64, v7, v39
    s_cmp_eq_u32 s65, 1
    s_cbranch_scc1 L_sf11
    buffer_store_dwordx4 v[36:39], v13, s[44:47], s62 offen sc1
    s_waitcnt vmcnt(0)
    s_branch L_sg11
L_sf11:
    buffer_store_dwordx4 v[36:39], v13, s[44:47], s62 offen
L_sg11:
L_S_nt:
L_S_nof:
    s_lshl_b32 s65, s58, 14
    s_lshl_b32 s63, s57, 11
    s_add_u32 s65, s65, s63
    s_lshl_b32 s63, s60, 8
    s_add_u32 s65, s65, s63
    s_add_u32 s65, s65, 2359296
    v_lshlrev_b32 v4, 2, v0
    v_and_b32 v5, 1, v2
    v_lshl_add_u32 v5, v5, 4, v3
    v_lshlrev_b32 v5, 2, v5
    v_lshrrev_b32 v1, 1, v2
    v_lshl_add_u32 v5, v1, 12, v5
    s_lshl_b32 s62, s57, 4
    s_lshl_b32 s63, s60, 1
    s_add_u32 s62, s62, s63
    s_lshl_b32 s62, s62, 12
    s_add_u32 s62, s62, 1572864
    s_lshl_b32 s63, s58, 7
    s_add_u32 s62, s62, s63
    v_add_u32 v0, 57344, v6
    s_mov_b32 s68, 0x400000
L_w12:
    ds_read_b32 v1, v10 offset:48
    s_waitcnt lgkmcnt(0)
    v_readfirstlane_b32 s69, v1
    s_cmp_eq_u32 s69, 8
    s_cbranch_scc1 L_wd12
    s_sleep 1
    s_sub_u32 s68, s68, 1
    s_cmp_lg_u32 s68, 0
    s_cbranch_scc1 L_w12
L_wd12:
    ds_read_b64_tr_b16 v[12:13], v0 offset:0
    ds_read_b64_tr_b16 v[14:15], v0 offset:3584
    ds_read_b64_tr_b16 v[16:17], v0 offset:32
    ds_read_b64_tr_b16 v[18:19], v0 offset:3616
    ds_read_b64_tr_b16 v[20:21], v0 offset:64
    ds_read_b64_tr_b16 v[22:23], v0 offset:3648
    ds_read_b64_tr_b16 v[24:25], v0 offset:96
    ds_read_b64_tr_b16 v[26:27], v0 offset:3680
    ds_read_b64_tr_b16 v[28:29], v0 offset:28672
    ds_read_b64_tr_b16 v[30:31], v0 offset:32256
    ds_read_b64_tr_b16 v[32:33], v0 offset:28704
    ds_read_b64_tr_b16 v[34:35], v0 offset:32288
    ds_read_b64_tr_b16 v[36:37], v0 offset:28736
    ds_read_b64_tr_b16 v[38:39], v0 offset:32320
    ds_read_b64_tr_b16 v[40:41], v0 offset:28768
    ds_read_b64_tr_b16 v[42:43], v0 offset:32352
    s_cmp_ge_u32 s58, 28
    s_cbranch_scc1 L_S_f1
    s_mov_b32 s68, 0x400000
L_w13:
    ds_read_b32 v1, v10 offset:8
    s_waitcnt lgkmcnt(0)
    v_readfirstlane_b32 s69, v1
    s_cmp_eq_u32 s69, 1
    s_cbranch_scc1 L_wd13
    s_sleep 1
    s_sub_u32 s68, s68, 1
    s_cmp_lg_u32 s68, 0
    s_cbranch_scc1 L_w13
L_wd13:
    buffer_load_dword v84, v4, s[44:47], s65 offen sc1
L_S_f1:
    ds_read_b32 v85, v10 offset:36
    s_mov_b32 s68, 0x400000
L_w14:
    ds_read_b32 v1, v10 offset:52
    s_waitcnt lgkmcnt(0)
    v_readfirstlane_b32 s69, v1
    s_cmp_eq_u32 s69, 2
    s_cbranch_scc1 L_wd14
    s_sleep 1
    s_sub_u32 s68, s68, 1
    s_cmp_lg_u32 s68, 0
    s_cbranch_scc1 L_w14
L_wd14:
    ds_read_b64_tr_b16 v[44:45], v6 offset:0
    ds_read_b64_tr_b16 v[46:47], v6 offset:3584
    ds_read_b64_tr_b16 v[48:49], v6 offset:32
    ds_read_b64_tr_b16 v[50:51], v6 offset:3616
    ds_read_b64_tr_b16 v[52:53], v6 offset:64
    ds_read_b64_tr_b16 v[54:55], v6 offset:3648
    ds_read_b64_tr_b16 v[56:57], v6 offset:96
    ds_read_b64_tr_b16 v[58:59], v6 offset:3680
    ds_read_b64_tr_b16 v[60:61], v6 offset:28672
    ds_read_b64_tr_b16 v[62:63], v6 offset:32256
    ds_read_b64_tr_b16 v[64:65], v6 offset:28704
    ds_read_b64_tr_b16 v[66:67], v6 offset:32288
    ds_read_b64_tr_b16 v[68:69], v6 offset:28736
    ds_read_b64_tr_b16 v[70:71], v6 offset:32320
    ds_read_b64_tr_b16 v[72:73], v6 offset:28768
    ds_read_b64_tr_b16 v[74:75], v6 offset:32352
    s_cmp_ge_u32 s58, 28
    s_cbranch_scc1 L_pd_nof
    s_mov_b32 s68, 0x40000
L_S_fp:
    s_waitcnt vmcnt(0)
    v_msad_u8 v1, v84, s28, 0
    v_cmp_ne_u32 vcc, 0, v1
    s_cbranch_vccz L_pd_nof
    buffer_load_dword v84, v4, s[44:47], s65 offen sc1
    s_sub_u32 s68, s68, 1
    s_cmp_lg_u32 s68, 0
    s_cbranch_scc1 L_S_fp
    s_waitcnt vmcnt(0)
L_pd_nof:
    v_and_b32 v84, 0xffffff00, v84
    s_mov_b32 s68, 0x400000
L_w15:
    ds_read_b32 v1, v10 offset:20
    s_waitcnt lgkmcnt(0)
    v_readfirstlane_b32 s69, v1
    s_cmp_eq_u32 s69, 4
    s_cbranch_scc1 L_wd15
    s_sub_u32 s68, s68, 1
    s_cmp_lg_u32 s68, 0
    s_cbranch_scc1 L_w15
L_wd15:
    s_setprio 3
    ds_read_b128 v[108:111], v8 offset:7168
    ds_read_b128 v[112:115], v8 offset:7232
    ds_read_b128 v[116:119], v8 offset:7296
    ds_read_b128 v[120:123], v8 offset:7360
    s_waitcnt lgkmcnt(3)
    v_mfma_f32_16x16x32_bf16 v[88:91], v[108:111], v[12:15], 0
    v_mfma_f32_16x16x32_bf16 v[92:95], v[108:111], v[16:19], 0
    v_mfma_f32_16x16x32_bf16 v[96:99], v[108:111], v[20:23], 0
    v_mfma_f32_16x16x32_bf16 v[100:103], v[108:111], v[24:27], 0
    s_waitcnt lgkmcnt(2)
    v_mfma_f32_16x16x32_bf16 v[88:91], v[112:115], v[28:31], v[88:91]
    v_mfma_f32_16x16x32_bf16 v[92:95], v[112:115], v[32:35], v[92:95]
    v_mfma_f32_16x16x32_bf16 v[96:99], v[112:115], v[36:39], v[96:99]
    v_mfma_f32_16x16x32_bf16 v[100:103], v[112:115], v[40:43], v[100:103]
    s_waitcnt lgkmcnt(1)
    v_mfma_f32_16x16x32_bf16 v[88:91], v[116:119], v[44:47], v[88:91]
    v_mfma_f32_16x16x32_bf16 v[92:95], v[116:119], v[48:51], v[92:95]
    v_mfma_f32_16x16x32_bf16 v[96:99], v[116:119], v[52:55], v[96:99]
    v_mfma_f32_16x16x32_bf16 v[100:103], v[116:119], v[56:59], v[100:103]
    s_waitcnt lgkmcnt(0)
    v_mfma_f32_16x16x32_bf16 v[88:91], v[120:123], v[60:63], v[88:91]
    v_mfma_f32_16x16x32_bf16 v[92:95], v[120:123], v[64:67], v[92:95]
    v_mfma_f32_16x16x32_bf16 v[96:99], v[120:123], v[68:71], v[96:99]
    v_mfma_f32_16x16x32_bf16 v[100:103], v[120:123], v[72:75], v[100:103]
    s_nop 5
    v_cndmask_b32 v4, v88, v92, s[48:49]
    v_cndmask_b32 v4, v4, v96, s[50:51]
    v_cndmask_b32 v4, v4, v100, s[52:53]
    v_fmac_f32 v4, v84, v85
    v_add_u32 v4, 0x80, v4
    v_bfi_b32 v4, s64, v7, v4
    buffer_store_dword v4, v5, s[44:47], s62 offen sc1
    s_waitcnt vmcnt(0)
    s_mov_b64 exec, 1
    ds_add_u32 v10, v11 offset:24
    s_mov_b64 exec, -1
    s_endpgm
L_V:
    v_add_u32 v8, 147456, v162
    v_lshrrev_b32 v9, 2, v3
    v_lshl_add_u32 v9, v2, 3, v9
    v_lshlrev_b32 v9, 7, v9
    v_and_b32 v10, 3, v3
    v_lshl_add_u32 v9, v10, 3, v9
    s_and_b32 s55, s60, 1
    s_lshl_b32 s61, s55, 6
    v_add_u32 v9, s61, v9
    v_lshlrev_b32 v10, 4, v2
    v_lshrrev_b32 v11, 3, v3
    v_lshl_add_u32 v10, v11, 6, v10
    v_and_b32 v11, 7, v3
    v_lshl_add_u32 v10, v11, 16, v10
    s_and_b32 s48, s31, 7
    s_lshr_b32 s49, s31, 3
    s_lshl_b32 s55, s55, 7
    s_lshl_b32 s53, s30, 13
    s_lshl_b32 s54, s49, 11
    s_add_u32 s53, s53, s54
    s_lshl_b32 s54, s48, 8
    s_add_u32 s53, s53, s54
    s_add_u32 s53, s53, s55
    s_lshl_b32 s54, s58, 11
    s_lshl_b32 s66, s57, 8
    s_add_u32 s54, s54, s66
    s_add_u32 s54, s54, s55
    s_add_u32 s54, s54, 524288
    v_lshrrev_b32 v4, 3, v3
    v_and_b32 v5, 7, v3
    v_lshl_add_u32 v6, v2, 1, v4
    v_lshlrev_b32 v6, 9, v6
    v_lshl_add_u32 v1, v5, 4, v6
    v_cmp_eq_u32 s[62:63], 1, v4
    v_lshl_add_u32 v6, v5, 3, v2
    v_lshlrev_b32 v6, 2, v6
    v_add_u32 v160, 256, v6
    v_lshrrev_b32 v4, 2, v3
    v_lshlrev_b32 v4, 5, v4
    v_lshl_add_u32 v4, v2, 3, v4
    s_lshl_b32 s61, s60, 10
    s_add_u32 s61, s61, 2048
    v_add_u32 v6, s61, v4
    v_and_b32 v7, 3, v3
    v_mov_b32 v161, 6144
    v_cmp_eq_u32 vcc, 0, v7
    s_nop 1
    v_cndmask_b32 v2, v161, v6, vcc
    v_cmp_eq_u32 vcc, 1, v7
    s_nop 1
    v_cndmask_b32 v3, v161, v6, vcc
    v_cmp_eq_u32 vcc, 2, v7
    s_nop 1
    v_cndmask_b32 v4, v161, v6, vcc
    v_cmp_eq_u32 vcc, 3, v7
    s_nop 1
    v_cndmask_b32 v5, v161, v6, vcc
    v_mov_b32 v0, v160
    v_mov_b32 v6, 0
    v_mov_b32 v163, 1
    s_mov_b32 s64, 0x05040100
    s_mov_b32 s65, 0x07060302
    s_waitcnt lgkmcnt(0)
    s_mov_b32 s36, s26
    s_mov_b32 s37, s27
    s_mov_b32 s38, 2883584
    s_mov_b32 s39, 0x20000
    s_mov_b32 s32, s8
    s_mov_b32 s33, s9
    s_mov_b32 s34, 134217728
    s_mov_b32 s35, 0x20000
    s_mov_b32 s40, s12
    s_mov_b32 s41, s13
    s_mov_b32 s42, 3670016
    s_mov_b32 s43, 0x20000
    s_mov_b32 s48, s18
    s_mov_b32 s49, s19
    s_mov_b32 s50, 1605632
    s_mov_b32 s51, 0x20000
    s_lshl_b32 s44, s30, 9
    s_lshl_b32 s45, s56, 6
    s_add_u32 s44, s44, s45
    s_mul_i32 s44, s44, 896
    s_mul_i32 s45, s58, 57344
    s_lshl_b32 s46, s57, 7
    s_cmp_lt_u32 s57, 7
    s_cselect_b32 s46, s46, 0x40000000
    s_add_u32 s45, s45, s46
    v_lshrrev_b32 v161, 7, v162
    v_mul_u32_u24 v161, 896, v161
    v_and_b32 v160, 0x70, v162
    v_add_u32 v161, v161, v160
    s_lshl_b32 s61, s59, 21
    s_add_u32 s61, s61, 0x180000
    s_lshl_b32 s66, s56, 7
    s_add_u32 s61, s61, s66
    s_lshl_b32 s66, s60, 17
    s_add_u32 s61, s61, s66
    s_add_u32 s67, s60, 8
    s_movk_i32 s55, 0xff
    s_setprio 2
    s_cmp_ge_u32 s60, 2
    s_cbranch_scc1 L_V_h
    s_mov_b32 s68, 0x400000
L_w16:
    ds_read_b32 v7, v6 offset:56
    s_waitcnt lgkmcnt(0)
    v_readfirstlane_b32 s69, v7
    s_cmp_eq_u32 s69, 1
    s_cbranch_scc1 L_wd16
    s_sub_u32 s68, s68, 1
    s_cmp_lg_u32 s68, 0
    s_cbranch_scc1 L_w16
L_wd16:
    ds_read_b32 v11, v6 offset:28
    ds_read_b128 v[16:19], v8 offset:0
    ds_read_b128 v[20:23], v8 offset:1024
    ds_read_b128 v[24:27], v8 offset:2048
    ds_read_b128 v[28:31], v8 offset:3072
    ds_read_b64_tr_b16 v[40:41], v9 offset:8192
    ds_read_b64_tr_b16 v[42:43], v9 offset:8704
    ds_read_b64_tr_b16 v[44:45], v9 offset:8224
    ds_read_b64_tr_b16 v[46:47], v9 offset:8736
    ds_read_b64_tr_b16 v[48:49], v9 offset:12288
    ds_read_b64_tr_b16 v[50:51], v9 offset:12800
    ds_read_b64_tr_b16 v[52:53], v9 offset:12320
    ds_read_b64_tr_b16 v[54:55], v9 offset:12832
    ds_read_b64_tr_b16 v[56:57], v9 offset:16384
    ds_read_b64_tr_b16 v[58:59], v9 offset:16896
    s_waitcnt lgkmcnt(8)
    v_mfma_f32_16x16x32_bf16 v[32:35], v[40:43], v[16:19], 0
    ds_read_b64_tr_b16 v[60:61], v9 offset:16416
    ds_read_b64_tr_b16 v[62:63], v9 offset:16928
    s_waitcnt lgkmcnt(8)
    v_mfma_f32_16x16x32_bf16 v[36:39], v[44:47], v[16:19], 0
    ds_read_b64_tr_b16 v[64:65], v9 offset:20480
    ds_read_b64_tr_b16 v[66:67], v9 offset:20992
    s_waitcnt lgkmcnt(8)
    v_mfma_f32_16x16x32_bf16 v[32:35], v[48:51], v[20:23], v[32:35]
    ds_read_b64_tr_b16 v[68:69], v9 offset:20512
    ds_read_b64_tr_b16 v[70:71], v9 offset:21024
    s_waitcnt lgkmcnt(8)
    v_mfma_f32_16x16x32_bf16 v[36:39], v[52:55], v[20:23], v[36:39]
    s_waitcnt lgkmcnt(6)
    v_mfma_f32_16x16x32_bf16 v[32:35], v[56:59], v[24:27], v[32:35]
    s_waitcnt lgkmcnt(4)
    v_mfma_f32_16x16x32_bf16 v[36:39], v[60:63], v[24:27], v[36:39]
    s_waitcnt lgkmcnt(2)
    v_mfma_f32_16x16x32_bf16 v[32:35], v[64:67], v[28:31], v[32:35]
    s_waitcnt lgkmcnt(0)
    v_mfma_f32_16x16x32_bf16 v[36:39], v[68:71], v[28:31], v[36:39]
    s_nop 7
    v_cndmask_b32 v12, v32, v36, s[62:63]
    v_cndmask_b32 v13, v33, v37, s[62:63]
    v_cndmask_b32 v14, v34, v38, s[62:63]
    v_cndmask_b32 v15, v35, v39, s[62:63]
    v_add_u32 v12, 0x80, v12
    v_add_u32 v13, 0x80, v13
    v_add_u32 v14, 0x80, v14
    v_add_u32 v15, 0x80, v15
    v_bfi_b32 v12, s55, v11, v12
    v_bfi_b32 v13, s55, v11, v13
    v_bfi_b32 v14, s55, v11, v14
    v_bfi_b32 v15, s55, v11, v15
    s_mov_b32 s68, 0x400000
L_w17:
    ds_read_b32 v7, v6 offset:72
    s_waitcnt lgkmcnt(0)
    v_readfirstlane_b32 s69, v7
    s_cmp_lg_u32 s69, 0
    s_cbranch_scc1 L_wd17
    s_sleep 1
    s_sub_u32 s68, s68, 1
    s_cmp_lg_u32 s68, 0
    s_cbranch_scc1 L_w17
L_wd17:
    s_cmp_eq_u32 s69, 1
    s_cbranch_scc1 L_V_pf53
    buffer_store_dwordx4 v[12:15], v10, s[36:39], s53 offen sc1
    s_waitcnt vmcnt(0)
    s_branch L_V_pg53
L_V_pf53:
    buffer_store_dwordx4 v[12:15], v10, s[36:39], s53 offen
L_V_pg53:
    s_branch L_V_noh
L_V_h:
    s_cmp_ge_u32 s58, 28
    s_cbranch_scc1 L_V_noh
    s_mov_b32 s68, 0x400000
L_w18:
    ds_read_b32 v7, v6 offset:60
    s_waitcnt lgkmcnt(0)
    v_readfirstlane_b32 s69, v7
    s_cmp_eq_u32 s69, 1
    s_cbranch_scc1 L_wd18
    s_sub_u32 s68, s68, 1
    s_cmp_lg_u32 s68, 0
    s_cbranch_scc1 L_w18
L_wd18:
    ds_read_b32 v11, v6 offset:28
    ds_read_b128 v[16:19], v8 offset:4096
    ds_read_b128 v[20:23], v8 offset:5120
    ds_read_b64_tr_b16 v[40:41], v9 offset:24576
    ds_read_b64_tr_b16 v[42:43], v9 offset:25088
    ds_read_b64_tr_b16 v[44:45], v9 offset:24608
    ds_read_b64_tr_b16 v[46:47], v9 offset:25120
    ds_read_b64_tr_b16 v[48:49], v9 offset:28672
    ds_read_b64_tr_b16 v[50:51], v9 offset:29184
    ds_read_b64_tr_b16 v[52:53], v9 offset:28704
    ds_read_b64_tr_b16 v[54:55], v9 offset:29216
    s_waitcnt lgkmcnt(6)
    v_mfma_f32_16x16x32_bf16 v[32:35], v[40:43], v[16:19], 0
    s_waitcnt lgkmcnt(4)
    v_mfma_f32_16x16x32_bf16 v[36:39], v[44:47], v[16:19], 0
    s_waitcnt lgkmcnt(2)
    v_mfma_f32_16x16x32_bf16 v[32:35], v[48:51], v[20:23], v[32:35]
    s_waitcnt lgkmcnt(0)
    v_mfma_f32_16x16x32_bf16 v[36:39], v[52:55], v[20:23], v[36:39]
    s_nop 7
    v_cndmask_b32 v12, v32, v36, s[62:63]
    v_cndmask_b32 v13, v33, v37, s[62:63]
    v_cndmask_b32 v14, v34, v38, s[62:63]
    v_cndmask_b32 v15, v35, v39, s[62:63]
    v_add_u32 v12, 0x80, v12
    v_add_u32 v13, 0x80, v13
    v_add_u32 v14, 0x80, v14
    v_add_u32 v15, 0x80, v15
    v_bfi_b32 v12, s55, v11, v12
    v_bfi_b32 v13, s55, v11, v13
    v_bfi_b32 v14, s55, v11, v14
    v_bfi_b32 v15, s55, v11, v15
    s_mov_b32 s68, 0x400000
L_w19:
    ds_read_b32 v7, v6 offset:72
    s_waitcnt lgkmcnt(0)
    v_readfirstlane_b32 s69, v7
    s_cmp_lg_u32 s69, 0
    s_cbranch_scc1 L_wd19
    s_sleep 1
    s_sub_u32 s68, s68, 1
    s_cmp_lg_u32 s68, 0
    s_cbranch_scc1 L_w19
L_wd19:
    s_cmp_eq_u32 s69, 1
    s_cbranch_scc1 L_V_pf54
    buffer_store_dwordx4 v[12:15], v10, s[36:39], s54 offen sc1
    s_waitcnt vmcnt(0)
    s_branch L_V_pg54
L_V_pf54:
    buffer_store_dwordx4 v[12:15], v10, s[36:39], s54 offen
L_V_pg54:
L_V_noh:
    s_setprio 0
    s_mov_b64 exec, 1
    ds_add_u32 v6, v163 offset:64
    s_mov_b64 exec, -1
    s_mov_b32 s68, 0x400000
L_w20:
    ds_read_b32 v7, v6 offset:12
    s_waitcnt lgkmcnt(0)
    v_readfirstlane_b32 s69, v7
    s_cmp_eq_u32 s69, s67
    s_cbranch_scc1 L_wd20
    s_sleep 1
    s_sub_u32 s68, s68, 1
    s_cmp_lg_u32 s68, 0
    s_cbranch_scc1 L_w20
L_wd20:
    s_waitcnt vmcnt(0)
    v_add_u32 v164, 4096, v1
    v_add_u32 v165, 8192, v1
    v_add_u32 v166, 12288, v1
    s_setprio 2
    s_cmp_eq_u32 s60, 1
    s_cbranch_scc1 L_V_i1
    s_cmp_eq_u32 s60, 2
    s_cbranch_scc1 L_V_i2
    s_cmp_eq_u32 s60, 3
    s_cbranch_scc1 L_V_i3
L_V_i0:
    buffer_load_dwordx4 v[8:11], v1, s[32:35], s61 offen nt
    s_mov_b32 m0, 155136
    s_nop 0
    buffer_load_dwordx4 v161, s[48:51], s45 offen nt lds
    s_add_u32 s45, s45, 7168
    s_mov_b32 m0, 118784
    s_add_u32 s46, s44, 28672
    buffer_load_dwordx4 v162, s[40:43], s46 offen offset:0 nt lds
    buffer_load_dwordx4 v[12:15], v164, s[32:35], s61 offen nt
    s_mov_b32 m0, 156160
    s_nop 0
    buffer_load_dwordx4 v161, s[48:51], s45 offen nt lds
    s_add_u32 s45, s45, 7168
    s_mov_b32 m0, 118784
    s_add_u32 s46, s44, 28672
    buffer_load_dwordx4 v162, s[40:43], s46 offen offset:1024 nt lds
    buffer_load_dwordx4 v[16:19], v165, s[32:35], s61 offen nt
    s_mov_b32 m0, 157184
    s_nop 0
    buffer_load_dwordx4 v161, s[48:51], s45 offen nt lds
    s_add_u32 s45, s45, 7168
    s_mov_b32 m0, 118784
    s_add_u32 s46, s44, 28672
    buffer_load_dwordx4 v162, s[40:43], s46 offen offset:2048 nt lds
    buffer_load_dwordx4 v[20:23], v166, s[32:35], s61 offen nt
    s_add_u32 s61, s61, 16384
    s_mov_b32 m0, 158208
    s_nop 0
    buffer_load_dwordx4 v161, s[48:51], s45 offen nt lds
    s_add_u32 s45, s45, 7168
    s_mov_b32 m0, 118784
    s_add_u32 s46, s44, 28672
    buffer_load_dwordx4 v162, s[40:43], s46 offen offset:3072 nt lds
    buffer_load_dwordx4 v[24:27], v1, s[32:35], s61 offen nt
    s_mov_b32 m0, 159232
    s_nop 0
    buffer_load_dwordx4 v161, s[48:51], s45 offen nt lds
    s_add_u32 s45, s45, 7168
    s_mov_b32 m0, 122880
    s_add_u32 s46, s44, 32768
    buffer_load_dwordx4 v162, s[40:43], s46 offen offset:0 nt lds
    buffer_load_dwordx4 v[28:31], v164, s[32:35], s61 offen nt
    s_mov_b32 m0, 160256
    s_nop 0
    buffer_load_dwordx4 v161, s[48:51], s45 offen nt lds
    s_add_u32 s45, s45, 7168
    s_mov_b32 m0, 122880
    s_add_u32 s46, s44, 32768
    buffer_load_dwordx4 v162, s[40:43], s46 offen offset:1024 nt lds
    buffer_load_dwordx4 v[32:35], v165, s[32:35], s61 offen nt
    s_mov_b32 m0, 161280
    s_nop 0
    buffer_load_dwordx4 v161, s[48:51], s45 offen nt lds
    s_add_u32 s45, s45, 7168
    s_mov_b32 m0, 122880
    s_add_u32 s46, s44, 32768
    buffer_load_dwordx4 v162, s[40:43], s46 offen offset:2048 nt lds
    buffer_load_dwordx4 v[36:39], v166, s[32:35], s61 offen nt
    s_add_u32 s61, s61, 16384
    s_mov_b32 m0, 162304
    s_nop 0
    buffer_load_dwordx4 v161, s[48:51], s45 offen nt lds
    s_add_u32 s45, s45, 7168
    s_mov_b32 m0, 122880
    s_add_u32 s46, s44, 32768
    buffer_load_dwordx4 v162, s[40:43], s46 offen offset:3072 nt lds
    buffer_load_dwordx4 v[40:43], v1, s[32:35], s61 offen nt
    s_mov_b32 m0, 126976
    s_add_u32 s46, s44, 36864
    buffer_load_dwordx4 v162, s[40:43], s46 offen offset:0 nt lds
    buffer_load_dwordx4 v[44:47], v164, s[32:35], s61 offen nt
    buffer_load_dwordx4 v162, s[40:43], s46 offen offset:1024 nt lds
    buffer_load_dwordx4 v[48:51], v165, s[32:35], s61 offen nt
    buffer_load_dwordx4 v162, s[40:43], s46 offen offset:2048 nt lds
    buffer_load_dwordx4 v[52:55], v166, s[32:35], s61 offen nt
    s_add_u32 s61, s61, 16384
    buffer_load_dwordx4 v162, s[40:43], s46 offen offset:3072 nt lds
    buffer_load_dwordx4 v[56:59], v1, s[32:35], s61 offen nt
    s_mov_b32 m0, 131072
    s_add_u32 s46, s44, 40960
    buffer_load_dwordx4 v162, s[40:43], s46 offen offset:0 nt lds
    buffer_load_dwordx4 v[60:63], v164, s[32:35], s61 offen nt
    buffer_load_dwordx4 v162, s[40:43], s46 offen offset:1024 nt lds
    buffer_load_dwordx4 v[64:67], v165, s[32:35], s61 offen nt
    buffer_load_dwordx4 v162, s[40:43], s46 offen offset:2048 nt lds
    buffer_load_dwordx4 v[68:71], v166, s[32:35], s61 offen nt
    s_add_u32 s61, s61, 16384
    buffer_load_dwordx4 v162, s[40:43], s46 offen offset:3072 nt lds
    buffer_load_dwordx4 v[72:75], v1, s[32:35], s61 offen nt
    s_mov_b32 m0, 135168
    s_add_u32 s46, s44, 45056
    buffer_load_dwordx4 v162, s[40:43], s46 offen offset:0 nt lds
    buffer_load_dwordx4 v[76:79], v164, s[32:35], s61 offen nt
    buffer_load_dwordx4 v162, s[40:43], s46 offen offset:1024 nt lds
    buffer_load_dwordx4 v[80:83], v165, s[32:35], s61 offen nt
    buffer_load_dwordx4 v162, s[40:43], s46 offen offset:2048 nt lds
    buffer_load_dwordx4 v[84:87], v166, s[32:35], s61 offen nt
    s_add_u32 s61, s61, 16384
    buffer_load_dwordx4 v162, s[40:43], s46 offen offset:3072 nt lds
    buffer_load_dwordx4 v[88:91], v1, s[32:35], s61 offen nt
    s_mov_b32 m0, 139264
    s_add_u32 s46, s44, 49152
    buffer_load_dwordx4 v162, s[40:43], s46 offen offset:0 nt lds
    buffer_load_dwordx4 v[92:95], v164, s[32:35], s61 offen nt
    buffer_load_dwordx4 v162, s[40:43], s46 offen offset:1024 nt lds
    buffer_load_dwordx4 v[96:99], v165, s[32:35], s61 offen nt
    buffer_load_dwordx4 v162, s[40:43], s46 offen offset:2048 nt lds
    buffer_load_dwordx4 v[100:103], v166, s[32:35], s61 offen nt
    s_add_u32 s61, s61, 16384
    buffer_load_dwordx4 v162, s[40:43], s46 offen offset:3072 nt lds
    buffer_load_dwordx4 v[104:107], v1, s[32:35], s61 offen nt
    s_mov_b32 m0, 143360
    s_add_u32 s46, s44, 53248
    buffer_load_dwordx4 v162, s[40:43], s46 offen offset:0 nt lds
    buffer_load_dwordx4 v[108:111], v164, s[32:35], s61 offen nt
    buffer_load_dwordx4 v162, s[40:43], s46 offen offset:1024 nt lds
    buffer_load_dwordx4 v[112:115], v165, s[32:35], s61 offen nt
    buffer_load_dwordx4 v162, s[40:43], s46 offen offset:2048 nt lds
    buffer_load_dwordx4 v[116:119], v166, s[32:35], s61 offen nt
    s_add_u32 s61, s61, 16384
    buffer_load_dwordx4 v162, s[40:43], s46 offen offset:3072 nt lds
    buffer_load_dwordx4 v[120:123], v1, s[32:35], s61 offen nt
    buffer_load_dwordx4 v[124:127], v164, s[32:35], s61 offen nt
    s_mov_b64 exec, 1
    ds_add_u32 v6, v163 offset:12
    s_mov_b64 exec, -1
    buffer_load_dwordx4 v[128:131], v165, s[32:35], s61 offen nt
    buffer_load_dwordx4 v[132:135], v166, s[32:35], s61 offen nt
    s_setprio 0
    s_waitcnt vmcnt(24)
    ds_write_b32 v6, v163 offset:76
    s_waitcnt vmcnt(4)
    s_mov_b64 exec, 1
    ds_add_u32 v6, v163 offset:48
    s_mov_b64 exec, -1
    s_branch L_V_join
L_V_i1:
    buffer_load_dwordx4 v[8:11], v1, s[32:35], s61 offen nt
    s_mov_b32 m0, 32768
    s_add_u32 s46, s44, 229376
    buffer_load_dwordx4 v162, s[40:43], s46 offen offset:0 nt lds
    buffer_load_dwordx4 v[12:15], v164, s[32:35], s61 offen nt
    buffer_load_dwordx4 v162, s[40:43], s46 offen offset:1024 nt lds
    buffer_load_dwordx4 v[16:19], v165, s[32:35], s61 offen nt
    buffer_load_dwordx4 v162, s[40:43], s46 offen offset:2048 nt lds
    buffer_load_dwordx4 v[20:23], v166, s[32:35], s61 offen nt
    s_add_u32 s61, s61, 16384
    buffer_load_dwordx4 v162, s[40:43], s46 offen offset:3072 nt lds
    buffer_load_dwordx4 v[24:27], v1, s[32:35], s61 offen nt
    s_mov_b32 m0, 36864
    s_add_u32 s46, s44, 233472
    buffer_load_dwordx4 v162, s[40:43], s46 offen offset:0 nt lds
    buffer_load_dwordx4 v[28:31], v164, s[32:35], s61 offen nt
    buffer_load_dwordx4 v162, s[40:43], s46 offen offset:1024 nt lds
    buffer_load_dwordx4 v[32:35], v165, s[32:35], s61 offen nt
    buffer_load_dwordx4 v162, s[40:43], s46 offen offset:2048 nt lds
    buffer_load_dwordx4 v[36:39], v166, s[32:35], s61 offen nt
    s_add_u32 s61, s61, 16384
    buffer_load_dwordx4 v162, s[40:43], s46 offen offset:3072 nt lds
    buffer_load_dwordx4 v[40:43], v1, s[32:35], s61 offen nt
    s_mov_b32 m0, 40960
    s_add_u32 s46, s44, 237568
    buffer_load_dwordx4 v162, s[40:43], s46 offen offset:0 nt lds
    buffer_load_dwordx4 v[44:47], v164, s[32:35], s61 offen nt
    buffer_load_dwordx4 v162, s[40:43], s46 offen offset:1024 nt lds
    buffer_load_dwordx4 v[48:51], v165, s[32:35], s61 offen nt
    buffer_load_dwordx4 v162, s[40:43], s46 offen offset:2048 nt lds
    buffer_load_dwordx4 v[52:55], v166, s[32:35], s61 offen nt
    s_add_u32 s61, s61, 16384
    buffer_load_dwordx4 v162, s[40:43], s46 offen offset:3072 nt lds
    buffer_load_dwordx4 v[56:59], v1, s[32:35], s61 offen nt
    s_mov_b32 m0, 45056
    s_add_u32 s46, s44, 241664
    buffer_load_dwordx4 v162, s[40:43], s46 offen offset:0 nt lds
    buffer_load_dwordx4 v[60:63], v164, s[32:35], s61 offen nt
    buffer_load_dwordx4 v162, s[40:43], s46 offen offset:1024 nt lds
    buffer_load_dwordx4 v[64:67], v165, s[32:35], s61 offen nt
    buffer_load_dwordx4 v162, s[40:43], s46 offen offset:2048 nt lds
    buffer_load_dwordx4 v[68:71], v166, s[32:35], s61 offen nt
    s_add_u32 s61, s61, 16384
    buffer_load_dwordx4 v162, s[40:43], s46 offen offset:3072 nt lds
    buffer_load_dwordx4 v[72:75], v1, s[32:35], s61 offen nt
    s_mov_b32 m0, 49152
    s_add_u32 s46, s44, 245760
    buffer_load_dwordx4 v162, s[40:43], s46 offen offset:0 nt lds
    buffer_load_dwordx4 v[76:79], v164, s[32:35], s61 offen nt
    buffer_load_dwordx4 v162, s[40:43], s46 offen offset:1024 nt lds
    buffer_load_dwordx4 v[80:83], v165, s[32:35], s61 offen nt
    buffer_load_dwordx4 v162, s[40:43], s46 offen offset:2048 nt lds
    buffer_load_dwordx4 v[84:87], v166, s[32:35], s61 offen nt
    s_add_u32 s61, s61, 16384
    buffer_load_dwordx4 v162, s[40:43], s46 offen offset:3072 nt lds
    buffer_load_dwordx4 v[88:91], v1, s[32:35], s61 offen nt
    s_mov_b32 m0, 53248
    s_add_u32 s46, s44, 249856
    buffer_load_dwordx4 v162, s[40:43], s46 offen offset:0 nt lds
    buffer_load_dwordx4 v[92:95], v164, s[32:35], s61 offen nt
    buffer_load_dwordx4 v162, s[40:43], s46 offen offset:1024 nt lds
    buffer_load_dwordx4 v[96:99], v165, s[32:35], s61 offen nt
    buffer_load_dwordx4 v162, s[40:43], s46 offen offset:2048 nt lds
    buffer_load_dwordx4 v[100:103], v166, s[32:35], s61 offen nt
    s_add_u32 s61, s61, 16384
    buffer_load_dwordx4 v162, s[40:43], s46 offen offset:3072 nt lds
    buffer_load_dwordx4 v[104:107], v1, s[32:35], s61 offen nt
    s_mov_b32 m0, 57344
    s_add_u32 s46, s44, 253952
    buffer_load_dwordx4 v162, s[40:43], s46 offen offset:0 nt lds
    buffer_load_dwordx4 v[108:111], v164, s[32:35], s61 offen nt
    buffer_load_dwordx4 v162, s[40:43], s46 offen offset:1024 nt lds
    buffer_load_dwordx4 v[112:115], v165, s[32:35], s61 offen nt
    buffer_load_dwordx4 v162, s[40:43], s46 offen offset:2048 nt lds
    buffer_load_dwordx4 v[116:119], v166, s[32:35], s61 offen nt
    s_add_u32 s61, s61, 16384
    buffer_load_dwordx4 v162, s[40:43], s46 offen offset:3072 nt lds
    buffer_load_dwordx4 v[120:123], v1, s[32:35], s61 offen nt
    buffer_load_dwordx4 v[124:127], v164, s[32:35], s61 offen nt
    s_mov_b64 exec, 1
    ds_add_u32 v6, v163 offset:12
    s_mov_b64 exec, -1
    buffer_load_dwordx4 v[128:131], v165, s[32:35], s61 offen nt
    buffer_load_dwordx4 v[132:135], v166, s[32:35], s61 offen nt
    s_setprio 0
    s_waitcnt vmcnt(4)
    s_mov_b64 exec, 1
    ds_add_u32 v6, v163 offset:52
    s_mov_b64 exec, -1
    s_branch L_V_join
L_V_i2:
    buffer_load_dwordx4 v[8:11], v1, s[32:35], s61 offen nt
    s_mov_b32 m0, 61440
    s_add_u32 s46, s44, 258048
    buffer_load_dwordx4 v162, s[40:43], s46 offen offset:0 nt lds
    buffer_load_dwordx4 v[12:15], v164, s[32:35], s61 offen nt
    buffer_load_dwordx4 v162, s[40:43], s46 offen offset:1024 nt lds
    buffer_load_dwordx4 v[16:19], v165, s[32:35], s61 offen nt
    buffer_load_dwordx4 v162, s[40:43], s46 offen offset:2048 nt lds
    buffer_load_dwordx4 v[20:23], v166, s[32:35], s61 offen nt
    s_add_u32 s61, s61, 16384
    buffer_load_dwordx4 v162, s[40:43], s46 offen offset:3072 nt lds
    buffer_load_dwordx4 v[24:27], v1, s[32:35], s61 offen nt
    s_mov_b32 m0, 65536
    s_add_u32 s46, s44, 262144
    buffer_load_dwordx4 v162, s[40:43], s46 offen offset:0 nt lds
    buffer_load_dwordx4 v[28:31], v164, s[32:35], s61 offen nt
    buffer_load_dwordx4 v162, s[40:43], s46 offen offset:1024 nt lds
    buffer_load_dwordx4 v[32:35], v165, s[32:35], s61 offen nt
    buffer_load_dwordx4 v162, s[40:43], s46 offen offset:2048 nt lds
    buffer_load_dwordx4 v[36:39], v166, s[32:35], s61 offen nt
    s_add_u32 s61, s61, 16384
    buffer_load_dwordx4 v162, s[40:43], s46 offen offset:3072 nt lds
    buffer_load_dwordx4 v[40:43], v1, s[32:35], s61 offen nt
    s_mov_b32 m0, 69632
    s_add_u32 s46, s44, 266240
    buffer_load_dwordx4 v162, s[40:43], s46 offen offset:0 nt lds
    buffer_load_dwordx4 v[44:47], v164, s[32:35], s61 offen nt
    buffer_load_dwordx4 v162, s[40:43], s46 offen offset:1024 nt lds
    buffer_load_dwordx4 v[48:51], v165, s[32:35], s61 offen nt
    buffer_load_dwordx4 v162, s[40:43], s46 offen offset:2048 nt lds
    buffer_load_dwordx4 v[52:55], v166, s[32:35], s61 offen nt
    s_add_u32 s61, s61, 16384
    buffer_load_dwordx4 v162, s[40:43], s46 offen offset:3072 nt lds
    buffer_load_dwordx4 v[56:59], v1, s[32:35], s61 offen nt
    s_mov_b32 m0, 73728
    s_add_u32 s46, s44, 270336
    buffer_load_dwordx4 v162, s[40:43], s46 offen offset:0 nt lds
    buffer_load_dwordx4 v[60:63], v164, s[32:35], s61 offen nt
    buffer_load_dwordx4 v162, s[40:43], s46 offen offset:1024 nt lds
    buffer_load_dwordx4 v[64:67], v165, s[32:35], s61 offen nt
    buffer_load_dwordx4 v162, s[40:43], s46 offen offset:2048 nt lds
    buffer_load_dwordx4 v[68:71], v166, s[32:35], s61 offen nt
    s_add_u32 s61, s61, 16384
    buffer_load_dwordx4 v162, s[40:43], s46 offen offset:3072 nt lds
    buffer_load_dwordx4 v[72:75], v1, s[32:35], s61 offen nt
    s_mov_b32 m0, 77824
    s_add_u32 s46, s44, 274432
    buffer_load_dwordx4 v162, s[40:43], s46 offen offset:0 nt lds
    buffer_load_dwordx4 v[76:79], v164, s[32:35], s61 offen nt
    buffer_load_dwordx4 v162, s[40:43], s46 offen offset:1024 nt lds
    buffer_load_dwordx4 v[80:83], v165, s[32:35], s61 offen nt
    buffer_load_dwordx4 v162, s[40:43], s46 offen offset:2048 nt lds
    buffer_load_dwordx4 v[84:87], v166, s[32:35], s61 offen nt
    s_add_u32 s61, s61, 16384
    buffer_load_dwordx4 v162, s[40:43], s46 offen offset:3072 nt lds
    buffer_load_dwordx4 v[88:91], v1, s[32:35], s61 offen nt
    s_mov_b32 m0, 81920
    s_add_u32 s46, s44, 278528
    buffer_load_dwordx4 v162, s[40:43], s46 offen offset:0 nt lds
    buffer_load_dwordx4 v[92:95], v164, s[32:35], s61 offen nt
    buffer_load_dwordx4 v162, s[40:43], s46 offen offset:1024 nt lds
    buffer_load_dwordx4 v[96:99], v165, s[32:35], s61 offen nt
    buffer_load_dwordx4 v162, s[40:43], s46 offen offset:2048 nt lds
    buffer_load_dwordx4 v[100:103], v166, s[32:35], s61 offen nt
    s_add_u32 s61, s61, 16384
    buffer_load_dwordx4 v162, s[40:43], s46 offen offset:3072 nt lds
    buffer_load_dwordx4 v[104:107], v1, s[32:35], s61 offen nt
    s_mov_b32 m0, 86016
    s_add_u32 s46, s44, 282624
    buffer_load_dwordx4 v162, s[40:43], s46 offen offset:0 nt lds
    buffer_load_dwordx4 v[108:111], v164, s[32:35], s61 offen nt
    buffer_load_dwordx4 v162, s[40:43], s46 offen offset:1024 nt lds
    buffer_load_dwordx4 v[112:115], v165, s[32:35], s61 offen nt
    buffer_load_dwordx4 v162, s[40:43], s46 offen offset:2048 nt lds
    buffer_load_dwordx4 v[116:119], v166, s[32:35], s61 offen nt
    s_add_u32 s61, s61, 16384
    buffer_load_dwordx4 v162, s[40:43], s46 offen offset:3072 nt lds
    buffer_load_dwordx4 v[120:123], v1, s[32:35], s61 offen nt
    buffer_load_dwordx4 v[124:127], v164, s[32:35], s61 offen nt
    s_mov_b64 exec, 1
    ds_add_u32 v6, v163 offset:12
    s_mov_b64 exec, -1
    buffer_load_dwordx4 v[128:131], v165, s[32:35], s61 offen nt
    buffer_load_dwordx4 v[132:135], v166, s[32:35], s61 offen nt
    s_setprio 0
    s_waitcnt vmcnt(4)
    s_mov_b64 exec, 1
    ds_add_u32 v6, v163 offset:52
    s_mov_b64 exec, -1
    s_branch L_V_join
L_V_i3:
    buffer_load_dwordx4 v[8:11], v1, s[32:35], s61 offen nt
    buffer_load_dwordx4 v[12:15], v164, s[32:35], s61 offen nt
    buffer_load_dwordx4 v[16:19], v165, s[32:35], s61 offen nt
    buffer_load_dwordx4 v[20:23], v166, s[32:35], s61 offen nt
    s_add_u32 s61, s61, 16384
    buffer_load_dwordx4 v[24:27], v1, s[32:35], s61 offen nt
    buffer_load_dwordx4 v[28:31], v164, s[32:35], s61 offen nt
    buffer_load_dwordx4 v[32:35], v165, s[32:35], s61 offen nt
    buffer_load_dwordx4 v[36:39], v166, s[32:35], s61 offen nt
    s_add_u32 s61, s61, 16384
    buffer_load_dwordx4 v[40:43], v1, s[32:35], s61 offen nt
    buffer_load_dwordx4 v[44:47], v164, s[32:35], s61 offen nt
    buffer_load_dwordx4 v[48:51], v165, s[32:35], s61 offen nt
    buffer_load_dwordx4 v[52:55], v166, s[32:35], s61 offen nt
    s_add_u32 s61, s61, 16384
    buffer_load_dwordx4 v[56:59], v1, s[32:35], s61 offen nt
    buffer_load_dwordx4 v[60:63], v164, s[32:35], s61 offen nt
    buffer_load_dwordx4 v[64:67], v165, s[32:35], s61 offen nt
    buffer_load_dwordx4 v[68:71], v166, s[32:35], s61 offen nt
    s_add_u32 s61, s61, 16384
    buffer_load_dwordx4 v[72:75], v1, s[32:35], s61 offen nt
    buffer_load_dwordx4 v[76:79], v164, s[32:35], s61 offen nt
    buffer_load_dwordx4 v[80:83], v165, s[32:35], s61 offen nt
    buffer_load_dwordx4 v[84:87], v166, s[32:35], s61 offen nt
    s_add_u32 s61, s61, 16384
    buffer_load_dwordx4 v[88:91], v1, s[32:35], s61 offen nt
    buffer_load_dwordx4 v[92:95], v164, s[32:35], s61 offen nt
    buffer_load_dwordx4 v[96:99], v165, s[32:35], s61 offen nt
    buffer_load_dwordx4 v[100:103], v166, s[32:35], s61 offen nt
    s_add_u32 s61, s61, 16384
    buffer_load_dwordx4 v[104:107], v1, s[32:35], s61 offen nt
    buffer_load_dwordx4 v[108:111], v164, s[32:35], s61 offen nt
    buffer_load_dwordx4 v[112:115], v165, s[32:35], s61 offen nt
    buffer_load_dwordx4 v[116:119], v166, s[32:35], s61 offen nt
    s_add_u32 s61, s61, 16384
    buffer_load_dwordx4 v[120:123], v1, s[32:35], s61 offen nt
    buffer_load_dwordx4 v[124:127], v164, s[32:35], s61 offen nt
    buffer_load_dwordx4 v[128:131], v165, s[32:35], s61 offen nt
    buffer_load_dwordx4 v[132:135], v166, s[32:35], s61 offen nt
    s_setprio 0
L_V_join:
    s_mov_b32 s68, 0x400000
L_w21:
    ds_read_b32 v7, v6 offset:8
    s_waitcnt lgkmcnt(0)
    v_readfirstlane_b32 s69, v7
    s_cmp_eq_u32 s69, 1
    s_cbranch_scc1 L_wd21
    s_sleep 1
    s_sub_u32 s68, s68, 1
    s_cmp_lg_u32 s68, 0
    s_cbranch_scc1 L_w21
L_wd21:
    s_setprio 2
    ds_read_b32 v7, v6 offset:32
    ds_read_b64_tr_b16 v[144:145], v2 offset:0
    ds_read_b64_tr_b16 v[146:147], v2 offset:128
    ds_read_b64_tr_b16 v[148:149], v3 offset:0
    ds_read_b64_tr_b16 v[150:151], v3 offset:128
    ds_read_b64_tr_b16 v[152:153], v4 offset:0
    ds_read_b64_tr_b16 v[154:155], v4 offset:128
    ds_read_b64_tr_b16 v[156:157], v5 offset:0
    ds_read_b64_tr_b16 v[158:159], v5 offset:128
    s_waitcnt vmcnt(24)
    v_perm_b32 v160, v12, v8, s64
    v_perm_b32 v161, v20, v16, s64
    v_perm_b32 v162, v28, v24, s64
    v_perm_b32 v163, v36, v32, s64
    v_perm_b32 v164, v12, v8, s65
    v_perm_b32 v165, v20, v16, s65
    v_perm_b32 v166, v28, v24, s65
    v_perm_b32 v167, v36, v32, s65
    s_waitcnt lgkmcnt(0)
    v_mfma_f32_16x16x32_bf16 v[136:139], v[144:147], v[160:163], 0
    s_nop 0
    v_mfma_f32_16x16x32_bf16 v[136:139], v[148:151], v[164:167], v[136:139]
    v_perm_b32 v160, v13, v9, s64
    v_perm_b32 v161, v21, v17, s64
    v_perm_b32 v162, v29, v25, s64
    v_perm_b32 v163, v37, v33, s64
    v_perm_b32 v164, v13, v9, s65
    v_perm_b32 v165, v21, v17, s65
    v_perm_b32 v166, v29, v25, s65
    v_perm_b32 v167, v37, v33, s65
    v_mfma_f32_16x16x32_bf16 v[136:139], v[152:155], v[160:163], v[136:139]
    s_nop 0
    v_mfma_f32_16x16x32_bf16 v[136:139], v[156:159], v[164:167], v[136:139]
    v_perm_b32 v160, v14, v10, s64
    v_perm_b32 v161, v22, v18, s64
    v_perm_b32 v162, v30, v26, s64
    v_perm_b32 v163, v38, v34, s64
    v_perm_b32 v164, v14, v10, s65
    v_perm_b32 v165, v22, v18, s65
    v_perm_b32 v166, v30, v26, s65
    v_perm_b32 v167, v38, v34, s65
    v_mfma_f32_16x16x32_bf16 v[140:143], v[144:147], v[160:163], 0
    s_nop 0
    v_mfma_f32_16x16x32_bf16 v[140:143], v[148:151], v[164:167], v[140:143]
    v_perm_b32 v160, v15, v11, s64
    v_perm_b32 v161, v23, v19, s64
    v_perm_b32 v162, v31, v27, s64
    v_perm_b32 v163, v39, v35, s64
    v_perm_b32 v164, v15, v11, s65
    v_perm_b32 v165, v23, v19, s65
    v_perm_b32 v166, v31, v27, s65
    v_perm_b32 v167, v39, v35, s65
    v_mfma_f32_16x16x32_bf16 v[140:143], v[152:155], v[160:163], v[140:143]
    s_nop 0
    v_mfma_f32_16x16x32_bf16 v[140:143], v[156:159], v[164:167], v[140:143]
    ds_read_b64_tr_b16 v[144:145], v2 offset:256
    ds_read_b64_tr_b16 v[146:147], v2 offset:384
    ds_read_b64_tr_b16 v[148:149], v3 offset:256
    ds_read_b64_tr_b16 v[150:151], v3 offset:384
    ds_read_b64_tr_b16 v[152:153], v4 offset:256
    ds_read_b64_tr_b16 v[154:155], v4 offset:384
    ds_read_b64_tr_b16 v[156:157], v5 offset:256
    ds_read_b64_tr_b16 v[158:159], v5 offset:384
    s_waitcnt vmcnt(16)
    v_perm_b32 v160, v44, v40, s64
    v_perm_b32 v161, v52, v48, s64
    v_perm_b32 v162, v60, v56, s64
    v_perm_b32 v163, v68, v64, s64
    v_perm_b32 v164, v44, v40, s65
    v_perm_b32 v165, v52, v48, s65
    v_perm_b32 v166, v60, v56, s65
    v_perm_b32 v167, v68, v64, s65
    s_waitcnt lgkmcnt(0)
    v_mfma_f32_16x16x32_bf16 v[136:139], v[144:147], v[160:163], v[136:139]
    s_nop 0
    v_mfma_f32_16x16x32_bf16 v[136:139], v[148:151], v[164:167], v[136:139]
    v_perm_b32 v160, v45, v41, s64
    v_perm_b32 v161, v53, v49, s64
    v_perm_b32 v162, v61, v57, s64
    v_perm_b32 v163, v69, v65, s64
    v_perm_b32 v164, v45, v41, s65
    v_perm_b32 v165, v53, v49, s65
    v_perm_b32 v166, v61, v57, s65
    v_perm_b32 v167, v69, v65, s65
    v_mfma_f32_16x16x32_bf16 v[136:139], v[152:155], v[160:163], v[136:139]
    s_nop 0
    v_mfma_f32_16x16x32_bf16 v[136:139], v[156:159], v[164:167], v[136:139]
    v_perm_b32 v160, v46, v42, s64
    v_perm_b32 v161, v54, v50, s64
    v_perm_b32 v162, v62, v58, s64
    v_perm_b32 v163, v70, v66, s64
    v_perm_b32 v164, v46, v42, s65
    v_perm_b32 v165, v54, v50, s65
    v_perm_b32 v166, v62, v58, s65
    v_perm_b32 v167, v70, v66, s65
    v_mfma_f32_16x16x32_bf16 v[140:143], v[144:147], v[160:163], v[140:143]
    s_nop 0
    v_mfma_f32_16x16x32_bf16 v[140:143], v[148:151], v[164:167], v[140:143]
    v_perm_b32 v160, v47, v43, s64
    v_perm_b32 v161, v55, v51, s64
    v_perm_b32 v162, v63, v59, s64
    v_perm_b32 v163, v71, v67, s64
    v_perm_b32 v164, v47, v43, s65
    v_perm_b32 v165, v55, v51, s65
    v_perm_b32 v166, v63, v59, s65
    v_perm_b32 v167, v71, v67, s65
    v_mfma_f32_16x16x32_bf16 v[140:143], v[152:155], v[160:163], v[140:143]
    s_nop 0
    v_mfma_f32_16x16x32_bf16 v[140:143], v[156:159], v[164:167], v[140:143]
    ds_read_b64_tr_b16 v[144:145], v2 offset:512
    ds_read_b64_tr_b16 v[146:147], v2 offset:640
    ds_read_b64_tr_b16 v[148:149], v3 offset:512
    ds_read_b64_tr_b16 v[150:151], v3 offset:640
    ds_read_b64_tr_b16 v[152:153], v4 offset:512
    ds_read_b64_tr_b16 v[154:155], v4 offset:640
    ds_read_b64_tr_b16 v[156:157], v5 offset:512
    ds_read_b64_tr_b16 v[158:159], v5 offset:640
    s_waitcnt vmcnt(8)
    v_perm_b32 v160, v76, v72, s64
    v_perm_b32 v161, v84, v80, s64
    v_perm_b32 v162, v92, v88, s64
    v_perm_b32 v163, v100, v96, s64
    v_perm_b32 v164, v76, v72, s65
    v_perm_b32 v165, v84, v80, s65
    v_perm_b32 v166, v92, v88, s65
    v_perm_b32 v167, v100, v96, s65
    s_waitcnt lgkmcnt(0)
    v_mfma_f32_16x16x32_bf16 v[136:139], v[144:147], v[160:163], v[136:139]
    s_nop 0
    v_mfma_f32_16x16x32_bf16 v[136:139], v[148:151], v[164:167], v[136:139]
    v_perm_b32 v160, v77, v73, s64
    v_perm_b32 v161, v85, v81, s64
    v_perm_b32 v162, v93, v89, s64
    v_perm_b32 v163, v101, v97, s64
    v_perm_b32 v164, v77, v73, s65
    v_perm_b32 v165, v85, v81, s65
    v_perm_b32 v166, v93, v89, s65
    v_perm_b32 v167, v101, v97, s65
    v_mfma_f32_16x16x32_bf16 v[136:139], v[152:155], v[160:163], v[136:139]
    s_nop 0
    v_mfma_f32_16x16x32_bf16 v[136:139], v[156:159], v[164:167], v[136:139]
    v_perm_b32 v160, v78, v74, s64
    v_perm_b32 v161, v86, v82, s64
    v_perm_b32 v162, v94, v90, s64
    v_perm_b32 v163, v102, v98, s64
    v_perm_b32 v164, v78, v74, s65
    v_perm_b32 v165, v86, v82, s65
    v_perm_b32 v166, v94, v90, s65
    v_perm_b32 v167, v102, v98, s65
    v_mfma_f32_16x16x32_bf16 v[140:143], v[144:147], v[160:163], v[140:143]
    s_nop 0
    v_mfma_f32_16x16x32_bf16 v[140:143], v[148:151], v[164:167], v[140:143]
    v_perm_b32 v160, v79, v75, s64
    v_perm_b32 v161, v87, v83, s64
    v_perm_b32 v162, v95, v91, s64
    v_perm_b32 v163, v103, v99, s64
    v_perm_b32 v164, v79, v75, s65
    v_perm_b32 v165, v87, v83, s65
    v_perm_b32 v166, v95, v91, s65
    v_perm_b32 v167, v103, v99, s65
    v_mfma_f32_16x16x32_bf16 v[140:143], v[152:155], v[160:163], v[140:143]
    s_nop 0
    v_mfma_f32_16x16x32_bf16 v[140:143], v[156:159], v[164:167], v[140:143]
    ds_read_b64_tr_b16 v[144:145], v2 offset:768
    ds_read_b64_tr_b16 v[146:147], v2 offset:896
    ds_read_b64_tr_b16 v[148:149], v3 offset:768
    ds_read_b64_tr_b16 v[150:151], v3 offset:896
    ds_read_b64_tr_b16 v[152:153], v4 offset:768
    ds_read_b64_tr_b16 v[154:155], v4 offset:896
    ds_read_b64_tr_b16 v[156:157], v5 offset:768
    ds_read_b64_tr_b16 v[158:159], v5 offset:896
    v_subrev_u32 v12, 256, v0
    v_lshrrev_b32 v12, 1, v12
    v_add_u32 v12, 7168, v12
    v_mbcnt_lo_u32_b32 v13, -1, 0
    v_mbcnt_hi_u32_b32 v13, -1, v13
    v_lshlrev_b32 v13, 4, v13
    s_lshl_b32 s66, s60, 10
    v_add_u32 v14, s66, v13
    v_mov_b32 v15, 1
    s_waitcnt vmcnt(0)
    v_perm_b32 v160, v108, v104, s64
    v_perm_b32 v161, v116, v112, s64
    v_perm_b32 v162, v124, v120, s64
    v_perm_b32 v163, v132, v128, s64
    v_perm_b32 v164, v108, v104, s65
    v_perm_b32 v165, v116, v112, s65
    v_perm_b32 v166, v124, v120, s65
    v_perm_b32 v167, v132, v128, s65
    s_waitcnt lgkmcnt(0)
    v_mfma_f32_16x16x32_bf16 v[136:139], v[144:147], v[160:163], v[136:139]
    s_nop 0
    v_mfma_f32_16x16x32_bf16 v[136:139], v[148:151], v[164:167], v[136:139]
    v_perm_b32 v160, v109, v105, s64
    v_perm_b32 v161, v117, v113, s64
    v_perm_b32 v162, v125, v121, s64
    v_perm_b32 v163, v133, v129, s64
    v_perm_b32 v164, v109, v105, s65
    v_perm_b32 v165, v117, v113, s65
    v_perm_b32 v166, v125, v121, s65
    v_perm_b32 v167, v133, v129, s65
    v_mfma_f32_16x16x32_bf16 v[136:139], v[152:155], v[160:163], v[136:139]
    s_nop 0
    v_mfma_f32_16x16x32_bf16 v[136:139], v[156:159], v[164:167], v[136:139]
    v_perm_b32 v160, v110, v106, s64
    v_perm_b32 v161, v118, v114, s64
    v_perm_b32 v162, v126, v122, s64
    v_perm_b32 v163, v134, v130, s64
    v_perm_b32 v164, v110, v106, s65
    v_perm_b32 v165, v118, v114, s65
    v_perm_b32 v166, v126, v122, s65
    v_perm_b32 v167, v134, v130, s65
    v_mfma_f32_16x16x32_bf16 v[140:143], v[144:147], v[160:163], v[140:143]
    s_nop 0
    v_mfma_f32_16x16x32_bf16 v[140:143], v[148:151], v[164:167], v[140:143]
    v_perm_b32 v160, v111, v107, s64
    v_perm_b32 v161, v119, v115, s64
    v_perm_b32 v162, v127, v123, s64
    v_perm_b32 v163, v135, v131, s64
    v_perm_b32 v164, v111, v107, s65
    v_perm_b32 v165, v119, v115, s65
    v_perm_b32 v166, v127, v123, s65
    v_perm_b32 v167, v135, v131, s65
    v_mfma_f32_16x16x32_bf16 v[140:143], v[152:155], v[160:163], v[140:143]
    s_nop 0
    v_mfma_f32_16x16x32_bf16 v[140:143], v[156:159], v[164:167], v[140:143]
    s_nop 7
    v_cndmask_b32 v160, v136, v138, s[62:63]
    v_cndmask_b32 v161, v137, v139, s[62:63]
    v_cndmask_b32 v162, v140, v142, s[62:63]
    v_cndmask_b32 v163, v141, v143, s[62:63]
    s_nop 0
    v_add_f32_dpp v160, v160, v160 row_ror:8 row_mask:0xf bank_mask:0xf
    v_add_f32_dpp v161, v161, v161 row_ror:8 row_mask:0xf bank_mask:0xf
    v_add_f32_dpp v162, v162, v162 row_ror:8 row_mask:0xf bank_mask:0xf
    v_add_f32_dpp v163, v163, v163 row_ror:8 row_mask:0xf bank_mask:0xf
    ds_write_b128 v14, v[160:163] offset:8192
    s_mov_b64 exec, 1
    ds_add_rtn_u32 v8, v6, v15 offset:68
    s_mov_b64 exec, -1
    s_waitcnt lgkmcnt(0)
    v_readfirstlane_b32 s66, v8
    s_cmp_lg_u32 s66, 3
    s_cbranch_scc1 L_V_end
    ds_read_b128 v[16:19], v13 offset:8192
    ds_read_b128 v[20:23], v13 offset:9216
    ds_read_b128 v[24:27], v13 offset:10240
    ds_read_b128 v[28:31], v13 offset:11264
    s_waitcnt lgkmcnt(2)
    v_add_f32 v16, v16, v20
    v_add_f32 v17, v17, v21
    v_add_f32 v18, v18, v22
    v_add_f32 v19, v19, v23
    s_waitcnt lgkmcnt(0)
    v_add_f32 v24, v24, v28
    v_add_f32 v25, v25, v29
    v_add_f32 v26, v26, v30
    v_add_f32 v27, v27, v31
    v_add_f32 v16, v16, v24
    v_add_f32 v17, v17, v25
    v_add_f32 v18, v18, v26
    v_add_f32 v19, v19, v27
    v_mul_f32 v16, v7, v16
    v_mul_f32 v17, v7, v17
    v_mul_f32 v18, v7, v18
    v_mul_f32 v19, v7, v19
    v_cvt_pk_bf16_f32 v16, v16, v16
    v_cvt_pk_bf16_f32 v17, v17, v17
    v_cvt_pk_bf16_f32 v18, v18, v18
    v_cvt_pk_bf16_f32 v19, v19, v19
    ds_write_b16 v12, v16 offset:0
    ds_write_b16 v12, v17 offset:128
    ds_write_b16 v12, v18 offset:8
    ds_write_b16 v12, v19 offset:136
    v_mov_b32 v15, 4
    ds_write_b32 v6, v15 offset:20
L_V_end:
    s_endpgm
L_code_end:
.section .rodata,"a"
.p2align 6
.amdhsa_kernel gated_mix__sliding_block_cached__dense_activation_silu__decode_kernel
  .amdhsa_next_free_vgpr 168
  .amdhsa_next_free_sgpr 96
  .amdhsa_accum_offset 168
  .amdhsa_group_segment_fixed_size 0
  .amdhsa_kernarg_size 96
  .amdhsa_user_sgpr_count 2
  .amdhsa_user_sgpr_kernarg_segment_ptr 1
  .amdhsa_system_sgpr_workgroup_id_x 1
.end_amdhsa_kernel
```
